```python
import torch

def _softmax(x, axis=-1):
    return torch.softmax(x, dim=axis)
def _gelu(x):
    return torch.nn.functional.gelu(x, approximate="tanh")
def _silu(x):
    return torch.nn.functional.silu(x)
def _sigmoid(x):
    return torch.sigmoid(x)
def _layernorm(x, axis=-1, eps=1e-5):
    m = x.mean(dim=axis, keepdim=True)
    v = x.var(dim=axis, keepdim=True, unbiased=False)
    return (x - m) / torch.sqrt(v + eps)
def _scatter_add(tgt, idx, src, axis=0):
    return tgt.clone().index_add_(axis, idx, src)
def _segment_sum(src, seg, n):
    out = torch.zeros((n,) + src.shape[1:], dtype=src.dtype)
    return out.index_add_(0, seg, src)
def _pad(x, pw):
    flat = tuple(v for pair in reversed(pw) for v in pair)
    return torch.nn.functional.pad(x, flat)

kernel_name = 'parallel_sum__gqa_block_cached__swiglu_ffn__decode'

def setup_inputs():

    _w = (lambda a: (lambda t: t.to(torch.bfloat16) if t.is_floating_point() else t)(torch.as_tensor(a)))
    def _A_setup():
        B, Sq, D = 2, 1, 576
        Hq, Hkv, Sk, Dh = 32, 16, 32768, 128
        assert Hq % Hkv == 0, (Hq, Hkv)
        return {
            "x": _w((lambda *s: torch.randn(*s, dtype=torch.bfloat16) * 0.05)(B, Sq, D)),
            "k_cache": _w((lambda *s: torch.randn(*s, dtype=torch.bfloat16) * 3.2)(B, Hkv, Sk, Dh)),
            "v_cache": _w((lambda *s: torch.randn(*s, dtype=torch.bfloat16) * 1.6)(B, Hkv, Sk, Dh)),
            "wq": _w((lambda *s: torch.randn(*s, dtype=torch.bfloat16) * 3.2)(D, Hq * Dh) * (D ** -0.5)),
            "wo": _w((lambda *s: torch.randn(*s, dtype=torch.bfloat16) * 1.6)(Hq * Dh, D) * ((Hq * Dh) ** -0.5)),
        }
    _A_in = _A_setup()

    def _B_setup():
        B, S, D, F = 2, 1, 576, 4608
        return {
            "x": _w((lambda *s: torch.randn(*s, dtype=torch.bfloat16) * 0.05)(B, S, D)),
            "w_gate": _w((lambda *s: torch.randn(*s, dtype=torch.bfloat16) * 0.05)(D, F)),
            "w_up": _w((lambda *s: torch.randn(*s, dtype=torch.bfloat16) * 0.05)(D, F)),
            "w_down": _w((lambda *s: torch.randn(*s, dtype=torch.bfloat16) * 0.05)(F, D)),
        }
    _B_in = _B_setup()

    return {
        "A_x": _A_in["x"],
        "A_k_cache": _A_in["k_cache"],
        "A_v_cache": _A_in["v_cache"],
        "A_wq": _A_in["wq"],
        "A_wo": _A_in["wo"],
        "B_x": _B_in["x"],
        "B_w_gate": _B_in["w_gate"],
        "B_w_up": _B_in["w_up"],
        "B_w_down": _B_in["w_down"],
    }

def reference(A_x, A_k_cache, A_v_cache, A_wq, A_wo, B_x, B_w_gate, B_w_up, B_w_down):
    def _A_ref(x, k_cache, v_cache, wq, wo):
        B, Sq, D = x.shape
        Hq, Dh = 32, 128
        Hkv = k_cache.shape[1]
        rep = Hq // Hkv
        q = (lambda x, *d: x.permute(*d))((x @ wq).reshape(B, Sq, Hq, Dh), 0, 2, 1, 3)
        k = (lambda x, n, axis: torch.repeat_interleave(x, n, dim=axis))(k_cache, rep, axis=1)
        v = (lambda x, n, axis: torch.repeat_interleave(x, n, dim=axis))(v_cache, rep, axis=1)
        scores = torch.einsum("bhqd,bhkd->bhqk", q, k) * (Dh ** -0.5)
        p = _softmax(scores, axis=-1)
        o = torch.einsum("bhqk,bhkd->bhqd", p, v)
        return (lambda x, *d: x.permute(*d))(o, 0, 2, 1, 3).reshape(B, Sq, Hq * Dh) @ wo

    def _B_ref(x, w_gate, w_up, w_down):
        g = _silu(x @ w_gate)
        u = x @ w_up
        return (g * u) @ w_down

    x = A_x
    xn = _layernorm(x, axis=-1)
    return x + _A_ref(xn, A_k_cache, A_v_cache, A_wq, A_wo) + _B_ref(xn, B_w_gate, B_w_up, B_w_down)
```

```asm
; @launch grid=(256,1,1) block=(512,1,1) lds=145408
.amdgcn_target "amdgcn-amd-amdhsa--gfx950"
.text
.globl parallel_sum__gqa_block_cached__swiglu_ffn__decode_kernel
.p2align 8
.type parallel_sum__gqa_block_cached__swiglu_ffn__decode_kernel,@function
parallel_sum__gqa_block_cached__swiglu_ffn__decode_kernel:
    s_load_dwordx16 s[16:31], s[0:1], 0
    s_load_dwordx8 s[32:39], s[0:1], 64
    s_cmp_ge_u32 s2, 256
    s_cbranch_scc1 M_end
    v_lshrrev_b32 v6, 6, v0
    v_and_b32 v1, 63, v0
    v_readfirstlane_b32 s3, v6
    s_lshr_b32 s7, s2, 3
    s_lshr_b32 s4, s2, 4
    s_and_b32 s5, s7, 1
    s_and_b32 s6, s2, 7
    s_mul_i32 s96, s7, 1
    s_mov_b32 s10, 0x3db504f3
    s_mov_b32 s11, 0x3fb8aa3b
    s_cmp_ge_u32 s3, 2
    s_cbranch_scc1 M_stream
    s_setprio 3
    s_add_u32 s8, s6, s7
    s_and_b32 s8, s8, 7
    s_and_b32 s60, s7, 3
    s_lshl_b32 s60, s60, 3
    s_lshr_b32 s61, 0x02020203, s60
    s_and_b32 s61, s61, 255
    s_lshr_b32 s62, 0x07050300, s60
    s_and_b32 s62, s62, 255
    s_lshr_b32 s63, 0x00010106, s60
    s_and_b32 s63, s63, 255
    s_lshr_b32 s64, 0x10090200, s60
    s_and_b32 s64, s64, 255
    s_lshr_b32 s65, s7, 2
    s_mul_i32 s59, s65, 9
    s_add_u32 s59, s59, s62
    s_add_u32 s59, s59, s8
    s_cmp_lt_u32 s8, s61
    s_cselect_b32 s58, 1, 0
    s_mul_i32 s66, s65, 24
    s_add_u32 s66, s66, s64
    s_add_u32 s66, s66, s8
    s_sub_u32 s66, s66, s63
    s_cmp_ge_u32 s8, s63
    s_cselect_b32 s60, 2, 0
    s_or_b32 s58, s58, s60
    s_cmp_eq_u32 s3, 0
    s_cbranch_scc1 M_s1
    v_mov_b32 v16, -1
    v_mov_b32 v17, -1
    v_mov_b32 v18, -1
    v_mov_b32 v19, -1
    v_lshlrev_b32 v8, 4, v1
    ds_write_b128 v8, v[16:19] offset:18432
    ds_write_b128 v8, v[16:19] offset:19456
    ds_write_b128 v8, v[16:19] offset:20480
    ds_write_b128 v8, v[16:19] offset:21504
    s_and_b32 s60, s6, 2
    s_lshl_b32 s60, s60, 1
    s_and_b32 s61, s6, 1
    s_lshl_b32 s61, s61, 7
    s_or_b32 s60, s60, s61
    s_and_b32 s61, s6, 4
    s_lshl_b32 s61, s61, 6
    s_or_b32 s60, s60, s61
    v_mov_b32 v10, s60
    v_add_u32 v250, s96, v1
    v_and_b32 v250, 3, v250
    v_and_b32 v251, 60, v1
    v_or_b32 v250, v250, v251
    v_and_or_b32 v10, v250, 3, v10
    v_lshrrev_b32 v11, 2, v250
    v_lshl_or_b32 v10, v11, 3, v10
    v_lshlrev_b32 v10, 1, v10
    v_lshl_or_b32 v10, v1, 11, v10
    v_add_u32 v11, 0x401, v10
    v_lshlrev_b32 v8, 3, v1
    s_mov_b32 exec_lo, 0xffffffff
    s_mov_b32 exec_hi, 0xff
    ds_write_b64 v8, v[10:11] offset:18432
    s_mov_b64 exec, -1
    v_mov_b32 v12, 4
    v_mov_b32 v13, 0
    v_mov_b32 v14, 0
    v_mov_b32 v15, 0
    v_mov_b32 v8, 2048
    ds_write_b64 v8, v[12:13]
    ds_write_b64 v8, v[12:13] offset:40
    ds_write_b64 v8, v[14:15] offset:16
    ds_write_b64 v8, v[14:15] offset:24
    ds_write_b64 v8, v[14:15] offset:32
    s_waitcnt lgkmcnt(0)
    s_barrier
    s_mov_b32 s44, s38
    s_mov_b32 s45, s39
    s_mov_b32 s46, 0x800000
    s_mov_b32 s47, 0x20000
    s_mov_b32 s27, s58
    s_lshl_b32 s57, s6, 2
    s_add_u32 s57, s57, s7
    s_and_b32 s57, s57, 31
    s_lshl_b32 s57, s57, 1
    s_add_u32 s57, s57, s3
    s_mul_i32 s56, s57, 57
    s_lshr_b32 s56, s56, 9
    s_mul_i32 s61, s56, 9
    s_sub_u32 s26, s57, s61
    s_cmp_ge_u32 s56, 4
    s_cselect_b32 s9, 1, 0
    s_cmp_eq_u32 s56, 7
    s_cselect_b32 s9, 2, s9
    s_mul_i32 s60, s3, 36864
    s_add_u32 s60, s60, 59392
    v_lshl_add_u32 v2, v1, 4, s60
    v_lshrrev_b32 v4, 4, v1
    v_bfe_u32 v7, v1, 2, 2
    v_lshl_add_u32 v3, v4, 3, v7
    v_lshlrev_b32 v3, 7, v3
    v_and_b32 v7, 3, v1
    v_lshl_add_u32 v3, v7, 3, v3
    v_add_u32 v3, s60, v3
    v_bfe_u32 v5, v1, 1, 2
    v_lshl_add_u32 v5, v5, 2, v4
    v_lshlrev_b32 v4, 4, v4
    s_mov_b32 s76, 0xcccccccc
    s_mov_b32 s77, 0xcccccccc
    s_mov_b32 s78, 0xf0f0f0f0
    s_mov_b32 s79, 0xf0f0f0f0
    s_branch M_w1
M_s1:
    v_lshrrev_b32 v6, 5, v1
    v_and_b32 v7, 31, v1
    v_mul_u32_u24 v6, 1152, v6
    v_lshl_add_u32 v6, v7, 2, v6
    s_mov_b32 s62, 8192
    v_lshrrev_b32 v56, 3, v1
    v_mul_lo_u32 v56, v56, s62
    v_and_b32 v7, 7, v1
    v_lshl_add_u32 v56, v7, 4, v56
    s_mul_i32 s61, s62, 64
    v_add_u32 v57, s61, v56
    v_add_u32 v58, s61, v57
    s_mul_i32 s60, s66, 21846
    s_lshr_b32 s60, s60, 16
    s_mul_i32 s61, s60, 3
    s_sub_u32 s57, s66, s61
    s_mul_i32 s68, s57, 1572864
    s_lshl_b32 s61, s60, 7
    s_add_u32 s68, s68, s61
    s_add_u32 s69, s68, 65536
    s_add_u32 s70, s69, 65536
    s_add_u32 s71, s70, 65536
    s_add_u32 s72, s71, 65536
    s_add_u32 s73, s72, 65536
    s_add_u32 s74, s73, 65536
    s_add_u32 s75, s74, 65536
    s_mul_i32 s63, s57, 384
    s_waitcnt lgkmcnt(0)
    s_mov_b32 s52, s16
    s_mov_b32 s53, s17
    s_mov_b32 s54, 0x900
    s_mov_b32 s55, 0x20000
    s_mov_b32 s44, s38
    s_mov_b32 s45, s39
    s_mov_b32 s46, 0x800000
    s_mov_b32 s47, 0x20000
    s_add_u32 s14, s38, 65536
    s_addc_u32 s15, s39, 0
    s_load_dwordx2 s[12:13], s[14:15], 0
    buffer_load_dword v46, v6, s[52:55], 0 offen offset:0
    buffer_load_dword v47, v6, s[52:55], 0 offen offset:128
    buffer_load_dword v48, v6, s[52:55], 0 offen offset:256
    buffer_load_dword v49, v6, s[52:55], 0 offen offset:384
    buffer_load_dword v50, v6, s[52:55], 0 offen offset:512
    buffer_load_dword v51, v6, s[52:55], 0 offen offset:640
    buffer_load_dword v52, v6, s[52:55], 0 offen offset:768
    buffer_load_dword v53, v6, s[52:55], 0 offen offset:896
    buffer_load_dword v54, v6, s[52:55], 0 offen offset:1024
    s_bitcmp1_b32 s58, 1
    s_cbranch_scc0 M_s3
    s_mov_b32 s40, s22
    s_mov_b32 s41, s23
    s_mov_b32 s42, 0x480000
    s_mov_b32 s43, 0x20000
    buffer_load_dwordx4 v[64:67], v56, s[40:43], s68 offen nt
    buffer_load_dwordx4 v[68:71], v56, s[40:43], s69 offen nt
    buffer_load_dwordx4 v[72:75], v56, s[40:43], s70 offen nt
    buffer_load_dwordx4 v[76:79], v56, s[40:43], s71 offen nt
    buffer_load_dwordx4 v[80:83], v56, s[40:43], s72 offen nt
    buffer_load_dwordx4 v[84:87], v56, s[40:43], s73 offen nt
    buffer_load_dwordx4 v[88:91], v56, s[40:43], s74 offen nt
    buffer_load_dwordx4 v[92:95], v56, s[40:43], s75 offen nt
    buffer_load_dwordx4 v[96:99], v57, s[40:43], s68 offen nt
    buffer_load_dwordx4 v[100:103], v57, s[40:43], s69 offen nt
    buffer_load_dwordx4 v[104:107], v57, s[40:43], s70 offen nt
    buffer_load_dwordx4 v[108:111], v57, s[40:43], s71 offen nt
    buffer_load_dwordx4 v[112:115], v57, s[40:43], s72 offen nt
    buffer_load_dwordx4 v[116:119], v57, s[40:43], s73 offen nt
    buffer_load_dwordx4 v[120:123], v57, s[40:43], s74 offen nt
    buffer_load_dwordx4 v[124:127], v57, s[40:43], s75 offen nt
    buffer_load_dwordx4 v[128:131], v58, s[40:43], s68 offen nt
    buffer_load_dwordx4 v[132:135], v58, s[40:43], s69 offen nt
    buffer_load_dwordx4 v[136:139], v58, s[40:43], s70 offen nt
    buffer_load_dwordx4 v[140:143], v58, s[40:43], s71 offen nt
    buffer_load_dwordx4 v[144:147], v58, s[40:43], s72 offen nt
    buffer_load_dwordx4 v[148:151], v58, s[40:43], s73 offen nt
    buffer_load_dwordx4 v[152:155], v58, s[40:43], s74 offen nt
    buffer_load_dwordx4 v[156:159], v58, s[40:43], s75 offen nt
    s_barrier
    s_mul_i32 s60, s3, 36864
    s_add_u32 s60, s60, 59392
    v_lshl_add_u32 v2, v1, 4, s60
    v_lshrrev_b32 v4, 4, v1
    v_bfe_u32 v7, v1, 2, 2
    v_lshl_add_u32 v3, v4, 3, v7
    v_lshlrev_b32 v3, 7, v3
    v_and_b32 v7, 3, v1
    v_lshl_add_u32 v3, v7, 3, v3
    v_add_u32 v3, s60, v3
    v_bfe_u32 v5, v1, 1, 2
    v_lshl_add_u32 v5, v5, 2, v4
    v_lshlrev_b32 v4, 4, v4
    s_mov_b32 s76, 0xcccccccc
    s_mov_b32 s77, 0xcccccccc
    s_mov_b32 s78, 0xf0f0f0f0
    s_mov_b32 s79, 0xf0f0f0f0
    s_waitcnt vmcnt(24)
    s_branch M_s4
M_s3:
    s_barrier
    s_mul_i32 s60, s3, 36864
    s_add_u32 s60, s60, 59392
    v_lshl_add_u32 v2, v1, 4, s60
    v_lshrrev_b32 v4, 4, v1
    v_bfe_u32 v7, v1, 2, 2
    v_lshl_add_u32 v3, v4, 3, v7
    v_lshlrev_b32 v3, 7, v3
    v_and_b32 v7, 3, v1
    v_lshl_add_u32 v3, v7, 3, v3
    v_add_u32 v3, s60, v3
    v_bfe_u32 v5, v1, 1, 2
    v_lshl_add_u32 v5, v5, 2, v4
    v_lshlrev_b32 v4, 4, v4
    s_mov_b32 s76, 0xcccccccc
    s_mov_b32 s77, 0xcccccccc
    s_mov_b32 s78, 0xf0f0f0f0
    s_mov_b32 s79, 0xf0f0f0f0
    s_waitcnt vmcnt(0)
M_s4:
    v_lshlrev_b32 v28, 16, v46
    v_and_b32 v29, 0xffff0000, v46
    v_lshlrev_b32 v30, 16, v47
    v_and_b32 v31, 0xffff0000, v47
    v_lshlrev_b32 v32, 16, v48
    v_and_b32 v33, 0xffff0000, v48
    v_lshlrev_b32 v34, 16, v49
    v_and_b32 v35, 0xffff0000, v49
    v_lshlrev_b32 v36, 16, v50
    v_and_b32 v37, 0xffff0000, v50
    v_lshlrev_b32 v38, 16, v51
    v_and_b32 v39, 0xffff0000, v51
    v_lshlrev_b32 v40, 16, v52
    v_and_b32 v41, 0xffff0000, v52
    v_lshlrev_b32 v42, 16, v53
    v_and_b32 v43, 0xffff0000, v53
    v_lshlrev_b32 v44, 16, v54
    v_and_b32 v45, 0xffff0000, v54
    v_add_f32 v8, v28, v29
    v_add_f32 v9, v30, v31
    v_add_f32 v8, v8, v32
    v_add_f32 v9, v9, v33
    v_add_f32 v8, v8, v34
    v_add_f32 v9, v9, v35
    v_add_f32 v8, v8, v36
    v_add_f32 v9, v9, v37
    v_add_f32 v8, v8, v38
    v_add_f32 v9, v9, v39
    v_add_f32 v8, v8, v40
    v_add_f32 v9, v9, v41
    v_add_f32 v8, v8, v42
    v_add_f32 v9, v9, v43
    v_add_f32 v8, v8, v44
    v_add_f32 v9, v9, v45
    v_add_f32 v8, v8, v9
    s_nop 1
    v_add_f32_dpp v8, v8, v8 quad_perm:[1,0,3,2] row_mask:0xf bank_mask:0xf
    s_nop 1
    v_add_f32_dpp v8, v8, v8 quad_perm:[2,3,0,1] row_mask:0xf bank_mask:0xf
    s_nop 1
    v_add_f32_dpp v8, v8, v8 row_half_mirror row_mask:0xf bank_mask:0xf
    s_nop 1
    v_add_f32_dpp v8, v8, v8 row_mirror row_mask:0xf bank_mask:0xf
    v_mov_b32 v9, v8
    s_nop 1
    v_permlane16_swap_b32 v9, v8
    v_add_f32 v8, v8, v9
    v_mul_f32 v8, 0x3ae38e39, v8
    v_sub_f32 v12, v28, v8
    v_sub_f32 v13, v29, v8
    v_mul_f32 v10, v12, v12
    v_mul_f32 v11, v13, v13
    v_sub_f32 v12, v30, v8
    v_sub_f32 v13, v31, v8
    v_fmac_f32 v10, v12, v12
    v_fmac_f32 v11, v13, v13
    v_sub_f32 v12, v32, v8
    v_sub_f32 v13, v33, v8
    v_fmac_f32 v10, v12, v12
    v_fmac_f32 v11, v13, v13
    v_sub_f32 v12, v34, v8
    v_sub_f32 v13, v35, v8
    v_fmac_f32 v10, v12, v12
    v_fmac_f32 v11, v13, v13
    v_sub_f32 v12, v36, v8
    v_sub_f32 v13, v37, v8
    v_fmac_f32 v10, v12, v12
    v_fmac_f32 v11, v13, v13
    v_sub_f32 v12, v38, v8
    v_sub_f32 v13, v39, v8
    v_fmac_f32 v10, v12, v12
    v_fmac_f32 v11, v13, v13
    v_sub_f32 v12, v40, v8
    v_sub_f32 v13, v41, v8
    v_fmac_f32 v10, v12, v12
    v_fmac_f32 v11, v13, v13
    v_sub_f32 v12, v42, v8
    v_sub_f32 v13, v43, v8
    v_fmac_f32 v10, v12, v12
    v_fmac_f32 v11, v13, v13
    v_sub_f32 v12, v44, v8
    v_sub_f32 v13, v45, v8
    v_fmac_f32 v10, v12, v12
    v_fmac_f32 v11, v13, v13
    v_add_f32 v10, v10, v11
    v_cvt_pk_bf16_f32 v8, v8, v8
    v_and_b32 v8, 0xffff0000, v8
    v_add_f32_dpp v10, v10, v10 quad_perm:[1,0,3,2] row_mask:0xf bank_mask:0xf
    s_nop 1
    v_add_f32_dpp v10, v10, v10 quad_perm:[2,3,0,1] row_mask:0xf bank_mask:0xf
    s_nop 1
    v_add_f32_dpp v10, v10, v10 row_half_mirror row_mask:0xf bank_mask:0xf
    s_nop 1
    v_add_f32_dpp v10, v10, v10 row_mirror row_mask:0xf bank_mask:0xf
    v_mov_b32 v9, v10
    s_nop 1
    v_permlane16_swap_b32 v9, v10
    v_add_f32 v10, v10, v9
    v_mul_f32 v10, 0x3ae38e39, v10
    v_cvt_pk_bf16_f32 v10, v10, v10
    v_and_b32 v10, 0xffff0000, v10
    v_add_f32 v10, 0x3727c5ac, v10
    v_cvt_pk_bf16_f32 v10, v10, v10
    v_and_b32 v10, 0xffff0000, v10
    v_sqrt_f32 v10, v10
    v_sub_f32 v28, v28, v8
    v_sub_f32 v29, v29, v8
    v_sub_f32 v30, v30, v8
    v_sub_f32 v31, v31, v8
    v_sub_f32 v32, v32, v8
    v_sub_f32 v33, v33, v8
    v_sub_f32 v34, v34, v8
    v_sub_f32 v35, v35, v8
    v_sub_f32 v36, v36, v8
    v_sub_f32 v37, v37, v8
    v_sub_f32 v38, v38, v8
    v_sub_f32 v39, v39, v8
    v_sub_f32 v40, v40, v8
    v_sub_f32 v41, v41, v8
    v_sub_f32 v42, v42, v8
    v_sub_f32 v43, v43, v8
    v_sub_f32 v44, v44, v8
    v_sub_f32 v45, v45, v8
    v_cvt_pk_bf16_f32 v10, v10, v10
    v_and_b32 v10, 0xffff0000, v10
    v_rcp_f32 v10, v10
    v_cvt_pk_bf16_f32 v12, v28, v29
    v_lshlrev_b32 v28, 16, v12
    v_and_b32 v29, 0xffff0000, v12
    v_cvt_pk_bf16_f32 v13, v30, v31
    v_lshlrev_b32 v30, 16, v13
    v_and_b32 v31, 0xffff0000, v13
    v_cvt_pk_bf16_f32 v12, v32, v33
    v_lshlrev_b32 v32, 16, v12
    v_and_b32 v33, 0xffff0000, v12
    v_cvt_pk_bf16_f32 v13, v34, v35
    v_lshlrev_b32 v34, 16, v13
    v_and_b32 v35, 0xffff0000, v13
    v_cvt_pk_bf16_f32 v12, v36, v37
    v_lshlrev_b32 v36, 16, v12
    v_and_b32 v37, 0xffff0000, v12
    v_cvt_pk_bf16_f32 v13, v38, v39
    v_lshlrev_b32 v38, 16, v13
    v_and_b32 v39, 0xffff0000, v13
    v_cvt_pk_bf16_f32 v12, v40, v41
    v_lshlrev_b32 v40, 16, v12
    v_and_b32 v41, 0xffff0000, v12
    v_cvt_pk_bf16_f32 v13, v42, v43
    v_lshlrev_b32 v42, 16, v13
    v_and_b32 v43, 0xffff0000, v13
    v_cvt_pk_bf16_f32 v12, v44, v45
    v_lshlrev_b32 v44, 16, v12
    v_and_b32 v45, 0xffff0000, v12
    v_mul_f32 v28, v28, v10
    v_mul_f32 v29, v29, v10
    v_mul_f32 v30, v30, v10
    v_mul_f32 v31, v31, v10
    v_mul_f32 v32, v32, v10
    v_mul_f32 v33, v33, v10
    v_mul_f32 v34, v34, v10
    v_mul_f32 v35, v35, v10
    v_mul_f32 v36, v36, v10
    v_mul_f32 v37, v37, v10
    v_mul_f32 v38, v38, v10
    v_mul_f32 v39, v39, v10
    v_mul_f32 v40, v40, v10
    v_mul_f32 v41, v41, v10
    v_mul_f32 v42, v42, v10
    v_mul_f32 v43, v43, v10
    v_mul_f32 v44, v44, v10
    v_mul_f32 v45, v45, v10
    v_cvt_pk_bf16_f32 v46, v28, v29
    ds_write_b32 v6, v46 offset:2304
    v_cvt_pk_bf16_f32 v47, v30, v31
    ds_write_b32 v6, v47 offset:2432
    v_cvt_pk_bf16_f32 v48, v32, v33
    ds_write_b32 v6, v48 offset:2560
    v_cvt_pk_bf16_f32 v49, v34, v35
    ds_write_b32 v6, v49 offset:2688
    v_cvt_pk_bf16_f32 v50, v36, v37
    ds_write_b32 v6, v50 offset:2816
    v_cvt_pk_bf16_f32 v51, v38, v39
    ds_write_b32 v6, v51 offset:2944
    v_cvt_pk_bf16_f32 v52, v40, v41
    ds_write_b32 v6, v52 offset:3072
    v_cvt_pk_bf16_f32 v53, v42, v43
    ds_write_b32 v6, v53 offset:3200
    v_cvt_pk_bf16_f32 v54, v44, v45
    ds_write_b32 v6, v54 offset:3328
    s_waitcnt lgkmcnt(0)
    s_add_u32 s12, s12, 1
    s_add_u32 s13, s13, 0x9e3779b9
    v_mov_b32 v10, s12
    v_mov_b32 v11, s13
    v_mov_b32 v9, 2048
    v_mov_b32 v8, 1
    ds_write_b64 v9, v[10:11] offset:8
    ds_write_b32 v9, v8 offset:16
    s_bitcmp1_b32 s58, 1
    s_cbranch_scc0 M_w0n
    v_and_b32 v14, 1, v1
    v_mul_u32_u24 v15, 1152, v14
    v_add3_u32 v15, v15, v4, s63
    ds_read_b128 v[28:31], v15 offset:2304
    ds_read_b128 v[32:35], v15 offset:2368
    ds_read_b128 v[36:39], v15 offset:2432
    ds_read_b128 v[40:43], v15 offset:2496
    ds_read_b128 v[44:47], v15 offset:2560
    ds_read_b128 v[48:51], v15 offset:2624
    v_lshlrev_b32 v14, 9, v14
    v_lshl_add_u32 v14, v5, 5, v14
    s_lshl_b32 s62, s66, 10
    s_add_u32 s62, s62, 2097152
    s_waitcnt vmcnt(0)
    ds_write_b128 v2, v[64:67] offset:0
    ds_write_b128 v2, v[68:71] offset:1024
    ds_write_b128 v2, v[72:75] offset:2048
    ds_write_b128 v2, v[76:79] offset:3072
    ds_write_b128 v2, v[80:83] offset:4096
    ds_write_b128 v2, v[84:87] offset:5120
    ds_write_b128 v2, v[88:91] offset:6144
    ds_write_b128 v2, v[92:95] offset:7168
    ds_write_b128 v2, v[96:99] offset:8192
    ds_write_b128 v2, v[100:103] offset:9216
    ds_write_b128 v2, v[104:107] offset:10240
    ds_write_b128 v2, v[108:111] offset:11264
    ds_write_b128 v2, v[112:115] offset:12288
    ds_write_b128 v2, v[116:119] offset:13312
    ds_write_b128 v2, v[120:123] offset:14336
    ds_write_b128 v2, v[124:127] offset:15360
    ds_write_b128 v2, v[128:131] offset:16384
    ds_write_b128 v2, v[132:135] offset:17408
    ds_write_b128 v2, v[136:139] offset:18432
    ds_write_b128 v2, v[140:143] offset:19456
    ds_write_b128 v2, v[144:147] offset:20480
    ds_write_b128 v2, v[148:151] offset:21504
    ds_write_b128 v2, v[152:155] offset:22528
    ds_write_b128 v2, v[156:159] offset:23552
    s_waitcnt lgkmcnt(0)
    ds_read_b64_tr_b16 v[64:65], v3 offset:0
    ds_read_b64_tr_b16 v[66:67], v3 offset:512
    ds_read_b64_tr_b16 v[68:69], v3 offset:32
    ds_read_b64_tr_b16 v[70:71], v3 offset:544
    ds_read_b64_tr_b16 v[72:73], v3 offset:64
    ds_read_b64_tr_b16 v[74:75], v3 offset:576
    ds_read_b64_tr_b16 v[76:77], v3 offset:96
    ds_read_b64_tr_b16 v[78:79], v3 offset:608
    ds_read_b64_tr_b16 v[80:81], v3 offset:4096
    ds_read_b64_tr_b16 v[82:83], v3 offset:4608
    ds_read_b64_tr_b16 v[84:85], v3 offset:4128
    ds_read_b64_tr_b16 v[86:87], v3 offset:4640
    ds_read_b64_tr_b16 v[88:89], v3 offset:4160
    ds_read_b64_tr_b16 v[90:91], v3 offset:4672
    ds_read_b64_tr_b16 v[92:93], v3 offset:4192
    ds_read_b64_tr_b16 v[94:95], v3 offset:4704
    ds_read_b64_tr_b16 v[96:97], v3 offset:8192
    ds_read_b64_tr_b16 v[98:99], v3 offset:8704
    ds_read_b64_tr_b16 v[100:101], v3 offset:8224
    ds_read_b64_tr_b16 v[102:103], v3 offset:8736
    ds_read_b64_tr_b16 v[104:105], v3 offset:8256
    ds_read_b64_tr_b16 v[106:107], v3 offset:8768
    ds_read_b64_tr_b16 v[108:109], v3 offset:8288
    ds_read_b64_tr_b16 v[110:111], v3 offset:8800
    ds_read_b64_tr_b16 v[112:113], v3 offset:12288
    ds_read_b64_tr_b16 v[114:115], v3 offset:12800
    ds_read_b64_tr_b16 v[116:117], v3 offset:12320
    ds_read_b64_tr_b16 v[118:119], v3 offset:12832
    ds_read_b64_tr_b16 v[120:121], v3 offset:12352
    ds_read_b64_tr_b16 v[122:123], v3 offset:12864
    ds_read_b64_tr_b16 v[124:125], v3 offset:12384
    ds_read_b64_tr_b16 v[126:127], v3 offset:12896
    ds_read_b64_tr_b16 v[128:129], v3 offset:16384
    ds_read_b64_tr_b16 v[130:131], v3 offset:16896
    ds_read_b64_tr_b16 v[132:133], v3 offset:16416
    ds_read_b64_tr_b16 v[134:135], v3 offset:16928
    ds_read_b64_tr_b16 v[136:137], v3 offset:16448
    ds_read_b64_tr_b16 v[138:139], v3 offset:16960
    ds_read_b64_tr_b16 v[140:141], v3 offset:16480
    ds_read_b64_tr_b16 v[142:143], v3 offset:16992
    ds_read_b64_tr_b16 v[144:145], v3 offset:20480
    ds_read_b64_tr_b16 v[146:147], v3 offset:20992
    ds_read_b64_tr_b16 v[148:149], v3 offset:20512
    ds_read_b64_tr_b16 v[150:151], v3 offset:21024
    ds_read_b64_tr_b16 v[152:153], v3 offset:20544
    ds_read_b64_tr_b16 v[154:155], v3 offset:21056
    ds_read_b64_tr_b16 v[156:157], v3 offset:20576
    ds_read_b64_tr_b16 v[158:159], v3 offset:21088
    s_waitcnt lgkmcnt(0)
    v_mfma_f32_16x16x32_bf16 v[208:211], v[64:67], v[28:31], 0
    v_mfma_f32_16x16x32_bf16 v[212:215], v[68:71], v[28:31], 0
    v_mfma_f32_16x16x32_bf16 v[216:219], v[72:75], v[28:31], 0
    v_mfma_f32_16x16x32_bf16 v[220:223], v[76:79], v[28:31], 0
    v_mfma_f32_16x16x32_bf16 v[208:211], v[80:83], v[32:35], v[208:211]
    v_mfma_f32_16x16x32_bf16 v[212:215], v[84:87], v[32:35], v[212:215]
    v_mfma_f32_16x16x32_bf16 v[216:219], v[88:91], v[32:35], v[216:219]
    v_mfma_f32_16x16x32_bf16 v[220:223], v[92:95], v[32:35], v[220:223]
    v_mfma_f32_16x16x32_bf16 v[208:211], v[96:99], v[36:39], v[208:211]
    v_mfma_f32_16x16x32_bf16 v[212:215], v[100:103], v[36:39], v[212:215]
    v_mfma_f32_16x16x32_bf16 v[216:219], v[104:107], v[36:39], v[216:219]
    v_mfma_f32_16x16x32_bf16 v[220:223], v[108:111], v[36:39], v[220:223]
    v_mfma_f32_16x16x32_bf16 v[208:211], v[112:115], v[40:43], v[208:211]
    v_mfma_f32_16x16x32_bf16 v[212:215], v[116:119], v[40:43], v[212:215]
    v_mfma_f32_16x16x32_bf16 v[216:219], v[120:123], v[40:43], v[216:219]
    v_mfma_f32_16x16x32_bf16 v[220:223], v[124:127], v[40:43], v[220:223]
    v_mfma_f32_16x16x32_bf16 v[208:211], v[128:131], v[44:47], v[208:211]
    v_mfma_f32_16x16x32_bf16 v[212:215], v[132:135], v[44:47], v[212:215]
    v_mfma_f32_16x16x32_bf16 v[216:219], v[136:139], v[44:47], v[216:219]
    v_mfma_f32_16x16x32_bf16 v[220:223], v[140:143], v[44:47], v[220:223]
    v_mfma_f32_16x16x32_bf16 v[208:211], v[144:147], v[48:51], v[208:211]
    v_mfma_f32_16x16x32_bf16 v[212:215], v[148:151], v[48:51], v[212:215]
    v_mfma_f32_16x16x32_bf16 v[216:219], v[152:155], v[48:51], v[216:219]
    v_mfma_f32_16x16x32_bf16 v[220:223], v[156:159], v[48:51], v[220:223]
    s_nop 5
    v_cndmask_b32 v208, v208, v212, s[76:77]
    s_nop 0
    v_cndmask_b32 v216, v216, v220, s[76:77]
    v_cndmask_b32 v209, v209, v213, s[76:77]
    v_cndmask_b32 v217, v217, v221, s[76:77]
    v_cndmask_b32 v210, v210, v214, s[76:77]
    v_cndmask_b32 v218, v218, v222, s[76:77]
    v_cndmask_b32 v211, v211, v215, s[76:77]
    v_cndmask_b32 v219, v219, v223, s[76:77]
    v_cndmask_b32 v224, v208, v216, s[78:79]
    v_cndmask_b32 v225, v209, v217, s[78:79]
    v_cndmask_b32 v226, v210, v218, s[78:79]
    v_cndmask_b32 v227, v211, v219, s[78:79]
    v_mov_b32 v20, v224
    v_mov_b32 v22, v225
    v_mov_b32 v24, v226
    v_mov_b32 v26, v227
    v_xor_b32 v21, s12, v22
    v_xor_b32 v23, s13, v20
    v_xor_b32 v25, s12, v26
    v_xor_b32 v27, s13, v24
    s_mov_b32 exec_lo, 0xff00ff
    s_mov_b32 exec_hi, 0xff00ff
    buffer_store_dwordx4 v[20:23], v14, s[44:47], s62 offen sc1
    buffer_store_dwordx4 v[24:27], v14, s[44:47], s62 offen offset:16 sc1
    s_mov_b64 exec, -1
    s_branch M_w0
M_w0n:
M_w0:
    v_mov_b32 v9, 2084
    s_mov_b32 s67, 0
L_fw_1:
    ds_read_b32 v8, v9
    s_waitcnt lgkmcnt(0)
    v_readfirstlane_b32 s60, v8
    s_cmp_ge_u32 s60, 4
    s_cbranch_scc1 L_fw_1_ok
    s_sleep 2
    s_add_u32 s67, s67, 1
    s_cmp_lt_u32 s67, 4194304
    s_cbranch_scc1 L_fw_1
L_fw_1_ok:
    v_mul_u32_u24 v13, 192, v4
    v_and_b32 v7, 15, v1
    v_lshl_add_u32 v13, v7, 5, v13
    s_mul_i32 s63, s4, 12288
    s_lshl_b32 s64, s5, 9
    s_add_u32 s63, s63, s64
    s_add_u32 s63, s63, 2097152
    s_mov_b32 s67, 0
L_pp_2:
    buffer_load_dwordx4 v[28:31], v13, s[44:47], s63 offen offset:0 sc1
    buffer_load_dwordx4 v[32:35], v13, s[44:47], s63 offen offset:16 sc1
    buffer_load_dwordx4 v[36:39], v13, s[44:47], s63 offen offset:1024 sc1
    buffer_load_dwordx4 v[40:43], v13, s[44:47], s63 offen offset:1040 sc1
    buffer_load_dwordx4 v[44:47], v13, s[44:47], s63 offen offset:2048 sc1
    buffer_load_dwordx4 v[48:51], v13, s[44:47], s63 offen offset:2064 sc1
    s_waitcnt vmcnt(0)
    v_bitop3_b32 v9, v29, v30, s12 bitop3:0x96
    v_bitop3_b32 v10, v31, v28, s13 bitop3:0x96
    v_or_b32 v8, v9, v10
    v_bitop3_b32 v9, v33, v34, s12 bitop3:0x96
    v_bitop3_b32 v10, v35, v32, s13 bitop3:0x96
    v_or3_b32 v8, v8, v9, v10
    v_bitop3_b32 v9, v37, v38, s12 bitop3:0x96
    v_bitop3_b32 v10, v39, v36, s13 bitop3:0x96
    v_or3_b32 v8, v8, v9, v10
    v_bitop3_b32 v9, v41, v42, s12 bitop3:0x96
    v_bitop3_b32 v10, v43, v40, s13 bitop3:0x96
    v_or3_b32 v8, v8, v9, v10
    v_bitop3_b32 v9, v45, v46, s12 bitop3:0x96
    v_bitop3_b32 v10, v47, v44, s13 bitop3:0x96
    v_or3_b32 v8, v8, v9, v10
    v_bitop3_b32 v9, v49, v50, s12 bitop3:0x96
    v_bitop3_b32 v10, v51, v48, s13 bitop3:0x96
    v_or3_b32 v8, v8, v9, v10
    v_cmp_ne_u32 vcc, 0, v8
    s_cbranch_vccz L_q_ok
    s_add_u32 s67, s67, 1
    s_cmp_lt_u32 s67, 262144
    s_cbranch_scc1 L_pp_2
L_q_ok:
    v_add_f32 v16, v28, v36
    v_add_f32 v16, v16, v44
    v_add_f32 v17, v30, v38
    v_add_f32 v17, v17, v46
    v_add_f32 v18, v32, v40
    v_add_f32 v18, v18, v48
    v_add_f32 v19, v34, v42
    v_add_f32 v19, v19, v50
    v_cvt_pk_bf16_f32 v12, v16, v17
    v_cvt_pk_bf16_f32 v13, v18, v19
    v_lshlrev_b32 v14, 3, v1
    ds_write_b64 v14, v[12:13] offset:6912
    v_mov_b32 v10, 2048
    v_mov_b32 v9, 1
    v_mov_b32 v11, 0x10000
    s_mov_b64 exec, 1
    ds_add_rtn_u32 v8, v10, v11 offset:40
    s_waitcnt lgkmcnt(0)
    ds_write_b64 v10, v[8:9]
    s_mov_b64 exec, -1
    s_waitcnt vmcnt(0)
    s_mov_b32 s27, s58
    s_lshl_b32 s57, s6, 2
    s_add_u32 s57, s57, s7
    s_and_b32 s57, s57, 31
    s_lshl_b32 s57, s57, 1
    s_add_u32 s57, s57, s3
    s_mul_i32 s56, s57, 57
    s_lshr_b32 s56, s56, 9
    s_mul_i32 s61, s56, 9
    s_sub_u32 s26, s57, s61
    s_cmp_ge_u32 s56, 4
    s_cselect_b32 s9, 1, 0
    s_cmp_eq_u32 s56, 7
    s_cselect_b32 s9, 2, s9
    s_lshr_b32 s62, s6, 1
    s_lshl_b32 s60, s56, 2
    s_add_u32 s60, s60, s62
    s_add_u32 s61, s57, 1
    s_mul_i32 s61, s61, 57
    s_lshr_b32 s61, s61, 9
    s_lshl_b32 s61, s61, 2
    s_add_u32 s61, s61, s62
    s_cmp_lg_u32 s9, 0
    s_cselect_b32 s60, s4, s60
    s_cselect_b32 s61, s4, s61
    v_mov_b32 v13, s4
    s_mov_b32 exec_lo, 0xffff0000
    s_mov_b32 exec_hi, 0x0
    v_mov_b32 v13, s60
    s_mov_b32 exec_lo, 0x0
    s_mov_b32 exec_hi, 0xffff
    v_mov_b32 v13, s61
    s_mov_b64 exec, -1
    v_and_b32 v7, 15, v1
    v_lshlrev_b32 v13, 8, v13
    v_lshl_add_u32 v13, v7, 4, v13
    s_mov_b32 s63, 327680
    s_mov_b32 s67, 0
L_pl_3:
    buffer_load_dwordx4 v[28:31], v13, s[44:47], s63 offen sc1
    s_waitcnt vmcnt(0)
    v_bitop3_b32 v9, v29, v30, s12 bitop3:0x96
    v_bitop3_b32 v10, v31, v28, s13 bitop3:0x96
    v_or_b32 v8, v9, v10
    v_cmp_ne_u32 vcc, 0, v8
    s_cbranch_vccz L_pl_3_ok
    s_sleep 32
    s_add_u32 s67, s67, 1
    s_cmp_lt_u32 s67, 262144
    s_cbranch_scc1 L_pl_3
L_pl_3_ok:
    v_mov_b32 v12, 2048
    s_mul_i32 s53, s7, 4352
    s_add_u32 s53, s53, 524288
    s_and_b32 s55, s6, 2
    s_lshl_b32 s55, s55, 1
    s_and_b32 s60, s6, 1
    s_lshl_b32 s60, s60, 7
    s_or_b32 s55, s55, s60
    s_and_b32 s60, s6, 4
    s_lshl_b32 s60, s60, 6
    s_or_b32 s55, s55, s60
    v_and_b32 v13, 7, v1
    v_add_u32 v13, 1, v13
    v_lshlrev_b32 v13, 2, v13
    s_mov_b32 s48, 80
    s_mov_b32 s67, 0
L_p1:
    ds_read_b32 v8, v12
    s_waitcnt lgkmcnt(0)
    v_readfirstlane_b32 s54, v8
    s_add_u32 s54, s54, 7
    s_and_b32 s54, s54, -2
    s_min_u32 s54, s54, 126
    s_cmp_gt_u32 s54, s48
    s_cbranch_scc1 L_top
    s_cmp_gt_u32 s48, 80
    s_cbranch_scc1 L_fl
    s_sleep 8
    s_add_u32 s67, s67, 1
    s_cmp_lt_u32 s67, 2097152
    s_cbranch_scc1 L_p1
    s_branch L_close
L_top:
    v_add_u32 v14, s48, v1
    v_lshrrev_b32 v17, 1, v14
    v_mov_b32 v10, s55
    v_add_u32 v250, s96, v17
    v_and_b32 v250, 3, v250
    v_and_b32 v251, 60, v17
    v_or_b32 v250, v250, v251
    v_and_or_b32 v10, v250, 3, v10
    v_lshrrev_b32 v15, 2, v250
    v_lshl_or_b32 v10, v15, 3, v10
    v_lshlrev_b32 v10, 1, v10
    v_and_or_b32 v10, v14, 1, v10
    v_lshl_or_b32 v10, v14, 10, v10
    v_lshlrev_b32 v11, 2, v14
    v_cmp_gt_u32 vcc, s54, v14
    s_mov_b32 s48, s54
    s_and_saveexec_b64 s[80:81], vcc
    ds_write_b32 v11, v10 offset:18432
    s_mov_b64 exec, -1
    s_cmp_ge_u32 s48, 126
    s_cbranch_scc1 L_lead
L_fl:
    buffer_load_dword v9, v13, s[44:47], s53 offen offset:12 sc1
    s_waitcnt vmcnt(0)
    v_cmp_ne_u32 vcc, 0, v9
    s_cbranch_vccnz L_close
    s_add_u32 s67, s67, 1
    s_cmp_lt_u32 s67, 2097152
    s_cbranch_scc1 L_p1
    s_branch L_close
L_lead:
L_close:
    s_lshr_b32 s60, s48, 1
    v_mov_b32 v9, s60
    s_lshl_b32 s60, s6, 2
    v_mov_b32 v10, s60
    s_mov_b64 exec, 1
    buffer_store_dword v9, v10, s[44:47], s53 offen offset:16 sc1
    s_mov_b64 exec, -1
    s_mov_b32 s49, s48
    v_add_u32 v14, 0, v1
    v_lshlrev_b32 v10, 2, v14
    ds_read_b32 v16, v10 offset:18432
    v_add_u32 v14, 64, v1
    v_lshlrev_b32 v11, 2, v14
    ds_read_b32 v17, v11 offset:18432
    s_lshl_b32 s60, s48, 2
    v_add_u32 v10, s60, v10
    v_add_u32 v11, s60, v11
    v_cmp_gt_u32 vcc, s49, v14
    s_waitcnt lgkmcnt(0)
    v_or_b32 v16, 0x100000, v16
    v_or_b32 v17, 0x100000, v17
    ds_write_b32 v10, v16 offset:18432
    s_and_saveexec_b64 s[80:81], vcc
    ds_write_b32 v11, v17 offset:18432
    s_mov_b64 exec, -1
    s_lshl_b32 s48, s48, 1
    s_call_b64 s[82:83], F_tp
    v_bfe_u32 v18, v1, 1, 3
    v_lshlrev_b32 v13, 2, v18
    s_mov_b32 s67, 0
    s_nop 0
L_pl_4:
    buffer_load_dword v19, v13, s[44:47], s53 offen offset:16 sc1
    s_waitcnt vmcnt(0)
    v_mov_b32 v8, v19
    v_cmp_eq_u32 vcc, 0, v8
    s_cbranch_vccz L_pl_4_ok
    s_sleep 32
    s_add_u32 s67, s67, 1
    s_cmp_lt_u32 s67, 262144
    s_cbranch_scc1 L_pl_4
L_pl_4_ok:
    v_and_b32 v16, 2, v18
    v_lshlrev_b32 v16, 1, v16
    v_and_b32 v15, 1, v18
    v_lshlrev_b32 v15, 7, v15
    v_or_b32 v16, v16, v15
    v_and_b32 v15, 4, v18
    v_lshlrev_b32 v15, 6, v15
    v_or_b32 v16, v16, v15
    v_lshrrev_b32 v17, 4, v1
    v_lshlrev_b32 v17, 1, v17
    v_and_or_b32 v17, v1, 1, v17
    v_add_u32 v17, 40, v17
    s_mov_b32 s51, 0
    v_mov_b32 v10, v16
    v_add_u32 v250, s96, v17
    v_and_b32 v250, 3, v250
    v_and_b32 v251, 60, v17
    v_or_b32 v250, v250, v251
    v_and_or_b32 v10, v250, 3, v10
    v_lshrrev_b32 v15, 2, v250
    v_lshl_or_b32 v10, v15, 3, v10
    v_cmp_ge_u32 vcc, v17, v19
    v_cmp_gt_u32 s[80:81], 64, v17
    s_and_b64 vcc, vcc, s[80:81]
    v_mbcnt_lo_u32_b32 v11, vcc_lo, 0
    v_mbcnt_hi_u32_b32 v11, vcc_hi, v11
    v_add_u32 v11, s51, v11
    v_lshlrev_b32 v11, 2, v11
    s_bcnt1_i32_b64 s60, vcc
    s_add_u32 s51, s51, s60
    s_and_saveexec_b64 s[80:81], vcc
    ds_write_b32 v11, v10 offset:0
    s_mov_b64 exec, -1
    v_add_u32 v17, 8, v17
    v_mov_b32 v10, v16
    v_add_u32 v250, s96, v17
    v_and_b32 v250, 3, v250
    v_and_b32 v251, 60, v17
    v_or_b32 v250, v250, v251
    v_and_or_b32 v10, v250, 3, v10
    v_lshrrev_b32 v15, 2, v250
    v_lshl_or_b32 v10, v15, 3, v10
    v_cmp_ge_u32 vcc, v17, v19
    v_cmp_gt_u32 s[80:81], 64, v17
    s_and_b64 vcc, vcc, s[80:81]
    v_mbcnt_lo_u32_b32 v11, vcc_lo, 0
    v_mbcnt_hi_u32_b32 v11, vcc_hi, v11
    v_add_u32 v11, s51, v11
    v_lshlrev_b32 v11, 2, v11
    s_bcnt1_i32_b64 s60, vcc
    s_add_u32 s51, s51, s60
    s_and_saveexec_b64 s[80:81], vcc
    ds_write_b32 v11, v10 offset:0
    s_mov_b64 exec, -1
    v_add_u32 v17, 8, v17
    v_mov_b32 v10, v16
    v_add_u32 v250, s96, v17
    v_and_b32 v250, 3, v250
    v_and_b32 v251, 60, v17
    v_or_b32 v250, v250, v251
    v_and_or_b32 v10, v250, 3, v10
    v_lshrrev_b32 v15, 2, v250
    v_lshl_or_b32 v10, v15, 3, v10
    v_cmp_ge_u32 vcc, v17, v19
    v_cmp_gt_u32 s[80:81], 64, v17
    s_and_b64 vcc, vcc, s[80:81]
    v_mbcnt_lo_u32_b32 v11, vcc_lo, 0
    v_mbcnt_hi_u32_b32 v11, vcc_hi, v11
    v_add_u32 v11, s51, v11
    v_lshlrev_b32 v11, 2, v11
    s_bcnt1_i32_b64 s60, vcc
    s_add_u32 s51, s51, s60
    s_and_saveexec_b64 s[80:81], vcc
    ds_write_b32 v11, v10 offset:0
    s_mov_b64 exec, -1
    v_add_u32 v17, 8, v17
    v_mov_b32 v12, 2048
    v_mov_b32 v13, 0
    s_mov_b32 s67, 0
    s_lshl_b32 s51, s51, 1
    s_mov_b32 s50, 4
    s_mov_b32 s54, 0
    s_branch L_ph3
L_sl:
    ds_read_b32 v8, v12
    s_waitcnt lgkmcnt(0)
    v_readfirstlane_b32 s54, v8
    s_add_u32 s54, s54, 3
    s_cmp_ge_u32 s54, s48
    s_cbranch_scc1 L_fetch
    s_sleep 2
    s_add_u32 s67, s67, 1
    s_cmp_lt_u32 s67, 2097152
    s_cbranch_scc1 L_sl
L_fetch:
    s_mov_b32 s54, s51
    s_add_u32 s60, s50, s49
    s_cmp_gt_u32 s60, 288
    s_cbranch_scc1 L_nof
    v_mov_b32 v9, s50
    s_mov_b64 exec, 1
    buffer_atomic_add v9, v13, s[44:47], s53 offen sc0
    s_mov_b64 exec, -1
    s_waitcnt vmcnt(0)
    v_readfirstlane_b32 s54, v9
    s_min_u32 s54, s54, s51
L_nof:
    s_sub_u32 s60, s51, s54
    s_min_u32 s60, s60, s50
    v_cmp_le_u32 vcc, s60, v1
    v_subrev_u32 v18, s60, v1
    s_nop 0
    v_cndmask_b32 v18, v1, v18, vcc
    v_add_u32 v15, s54, v18
    v_lshrrev_b32 v14, 1, v15
    v_lshlrev_b32 v14, 2, v14
    ds_read_b32 v10, v14 offset:0
    v_and_b32 v15, 1, v15
    v_add_u32 v18, s49, v18
    v_lshl_or_b32 v15, v18, 10, v15
    v_or_b32 v17, 0x100000, v15
    v_cndmask_b32 v15, v15, v17, vcc
    s_add_u32 s49, s49, s60
    s_lshl_b32 s60, s60, 1
    v_add_u32 v11, s48, v1
    v_lshlrev_b32 v11, 2, v11
    v_cmp_gt_u32 vcc, s60, v1
    s_add_u32 s48, s48, s60
    s_waitcnt lgkmcnt(0)
    v_lshl_or_b32 v10, v10, 1, v15
    s_and_saveexec_b64 s[80:81], vcc
    ds_write_b32 v11, v10 offset:18432
    s_mov_b64 exec, -1
    s_add_u32 s54, s54, s50
L_ph3:
    s_add_u32 s60, s54, 80
    s_cmp_ge_u32 s60, s51
    s_cselect_b32 s50, 2, s50
    s_add_u32 s60, s54, 20
    s_cmp_ge_u32 s60, s51
    s_cselect_b32 s50, 1, s50
    s_cmp_lt_u32 s54, s51
    s_cbranch_scc1 L_sl
    v_mov_b32 v10, 0x40000000
    v_add_u32 v11, s48, v1
    v_lshlrev_b32 v11, 2, v11
    ds_write_b32 v11, v10 offset:18432
    v_mov_b32 v9, 2068
    v_mov_b32 v8, 1
    ds_write_b32 v9, v8
    s_cmp_eq_u32 s9, 0
    s_cselect_b32 s61, -2, -2
    s_mov_b32 s67, 0
L_se_5:
    ds_read_b32 v8, v12
    s_waitcnt lgkmcnt(0)
    v_readfirstlane_b32 s54, v8
    s_add_u32 s54, s54, s61
    s_cmp_ge_u32 s54, s48
    s_cbranch_scc1 L_se_5_ok
    s_sleep 1
    s_add_u32 s67, s67, 1
    s_cmp_lt_u32 s67, 2097152
    s_cbranch_scc1 L_se_5
L_se_5_ok:
    v_mov_b32 v9, 2072
    v_mov_b32 v8, 1
    ds_write_b32 v9, v8
    s_call_b64 s[82:83], F_tl
M_tail:
    s_cmp_lg_u32 s9, 0
    s_cbranch_scc1 M_wd
    v_and_b32 v12, 15, v1
    v_lshlrev_b32 v12, 3, v12
    buffer_load_dword v11, v12, s[44:47], s15 offen sc1
    buffer_load_dwordx4 v[160:163], v198, s[44:47], s15 offen offset:0 sc1
    buffer_load_dwordx4 v[164:167], v198, s[44:47], s15 offen offset:16 sc1
    buffer_load_dwordx4 v[168:171], v198, s[44:47], s15 offen offset:32 sc1
    buffer_load_dwordx4 v[172:175], v198, s[44:47], s15 offen offset:48 sc1
    buffer_load_dwordx4 v[128:131], v194, s[44:47], s14 offen offset:0 sc1
    buffer_load_dwordx4 v[132:135], v194, s[44:47], s14 offen offset:2048 sc1
    buffer_load_dwordx4 v[136:139], v195, s[44:47], s14 offen offset:0 sc1
    buffer_load_dwordx4 v[140:143], v195, s[44:47], s14 offen offset:2048 sc1
    buffer_load_dwordx4 v[144:147], v196, s[44:47], s14 offen offset:0 sc1
    buffer_load_dwordx4 v[148:151], v196, s[44:47], s14 offen offset:2048 sc1
    buffer_load_dwordx4 v[152:155], v197, s[44:47], s14 offen offset:0 sc1
    buffer_load_dwordx4 v[156:159], v197, s[44:47], s14 offen offset:2048 sc1
    s_waitcnt vmcnt(13)
    ds_write_b128 v2, v[64:67] offset:0
    ds_write_b128 v2, v[68:71] offset:1024
    ds_write_b128 v2, v[72:75] offset:2048
    ds_write_b128 v2, v[76:79] offset:3072
    ds_write_b128 v2, v[80:83] offset:4096
    ds_write_b128 v2, v[84:87] offset:5120
    ds_write_b128 v2, v[88:91] offset:6144
    ds_write_b128 v2, v[92:95] offset:7168
    ds_write_b128 v2, v[96:99] offset:8192
    ds_write_b128 v2, v[100:103] offset:9216
    ds_write_b128 v2, v[104:107] offset:10240
    ds_write_b128 v2, v[108:111] offset:11264
    ds_write_b128 v2, v[112:115] offset:12288
    ds_write_b128 v2, v[116:119] offset:13312
    ds_write_b128 v2, v[120:123] offset:14336
    ds_write_b128 v2, v[124:127] offset:15360
    s_waitcnt lgkmcnt(0)
    ds_read_b64_tr_b16 v[64:65], v3 offset:0
    ds_read_b64_tr_b16 v[66:67], v3 offset:512
    ds_read_b64_tr_b16 v[68:69], v3 offset:32
    ds_read_b64_tr_b16 v[70:71], v3 offset:544
    ds_read_b64_tr_b16 v[72:73], v3 offset:64
    ds_read_b64_tr_b16 v[74:75], v3 offset:576
    ds_read_b64_tr_b16 v[76:77], v3 offset:96
    ds_read_b64_tr_b16 v[78:79], v3 offset:608
    ds_read_b64_tr_b16 v[80:81], v3 offset:4096
    ds_read_b64_tr_b16 v[82:83], v3 offset:4608
    ds_read_b64_tr_b16 v[84:85], v3 offset:4128
    ds_read_b64_tr_b16 v[86:87], v3 offset:4640
    ds_read_b64_tr_b16 v[88:89], v3 offset:4160
    ds_read_b64_tr_b16 v[90:91], v3 offset:4672
    ds_read_b64_tr_b16 v[92:93], v3 offset:4192
    ds_read_b64_tr_b16 v[94:95], v3 offset:4704
    ds_read_b64_tr_b16 v[96:97], v3 offset:8192
    ds_read_b64_tr_b16 v[98:99], v3 offset:8704
    ds_read_b64_tr_b16 v[100:101], v3 offset:8224
    ds_read_b64_tr_b16 v[102:103], v3 offset:8736
    ds_read_b64_tr_b16 v[104:105], v3 offset:8256
    ds_read_b64_tr_b16 v[106:107], v3 offset:8768
    ds_read_b64_tr_b16 v[108:109], v3 offset:8288
    ds_read_b64_tr_b16 v[110:111], v3 offset:8800
    ds_read_b64_tr_b16 v[112:113], v3 offset:12288
    ds_read_b64_tr_b16 v[114:115], v3 offset:12800
    ds_read_b64_tr_b16 v[116:117], v3 offset:12320
    ds_read_b64_tr_b16 v[118:119], v3 offset:12832
    ds_read_b64_tr_b16 v[120:121], v3 offset:12352
    ds_read_b64_tr_b16 v[122:123], v3 offset:12864
    ds_read_b64_tr_b16 v[124:125], v3 offset:12384
    ds_read_b64_tr_b16 v[126:127], v3 offset:12896
    s_waitcnt vmcnt(0)
    v_max3_u32 v8, v128, v129, v130
    v_max3_u32 v9, v131, v132, v133
    v_max3_u32 v8, v8, v134, v135
    v_max3_u32 v9, v9, v136, v137
    v_max3_u32 v8, v8, v138, v139
    v_max3_u32 v9, v9, v140, v141
    v_max3_u32 v8, v8, v142, v143
    v_max3_u32 v9, v9, v144, v145
    v_max3_u32 v8, v8, v146, v147
    v_max3_u32 v9, v9, v148, v149
    v_max3_u32 v8, v8, v150, v151
    v_max3_u32 v9, v9, v152, v153
    v_max3_u32 v8, v8, v154, v155
    v_max3_u32 v9, v9, v156, v157
    v_max3_u32 v8, v8, v158, v159
    v_max3_u32 v9, v9, v160, v161
    v_max3_u32 v8, v8, v162, v163
    v_max3_u32 v9, v9, v164, v165
    v_max3_u32 v8, v8, v166, v167
    v_max3_u32 v9, v9, v168, v169
    v_max3_u32 v8, v8, v170, v171
    v_max3_u32 v9, v9, v172, v173
    v_max3_u32 v8, v8, v174, v175
    v_max_u32 v8, v8, v9
    v_cmp_eq_u32 vcc, -1, v8
    s_cbranch_vccz L_hop_ok
    s_mov_b32 s67, 0
L_h1:
    v_cmp_ne_u32 vcc, -1, v11
    s_bcnt1_i32_b64 s60, vcc
    s_cmp_ge_u32 s60, 56
    s_cbranch_scc1 L_h1_ok
    buffer_load_dword v11, v12, s[44:47], s15 offen sc1
    s_waitcnt vmcnt(0)
    s_add_u32 s67, s67, 1
    s_cmp_lt_u32 s67, 262144
    s_cbranch_scc1 L_h1
L_h1_ok:
    s_mov_b32 s67, 0
    buffer_load_dwordx4 v[160:163], v198, s[44:47], s15 offen offset:0 sc1
    buffer_load_dwordx4 v[164:167], v198, s[44:47], s15 offen offset:16 sc1
    buffer_load_dwordx4 v[168:171], v198, s[44:47], s15 offen offset:32 sc1
    buffer_load_dwordx4 v[172:175], v198, s[44:47], s15 offen offset:48 sc1
    buffer_load_dwordx4 v[128:131], v194, s[44:47], s14 offen offset:0 sc1
    buffer_load_dwordx4 v[132:135], v194, s[44:47], s14 offen offset:2048 sc1
    buffer_load_dwordx4 v[136:139], v195, s[44:47], s14 offen offset:0 sc1
    buffer_load_dwordx4 v[140:143], v195, s[44:47], s14 offen offset:2048 sc1
    buffer_load_dwordx4 v[144:147], v196, s[44:47], s14 offen offset:0 sc1
    buffer_load_dwordx4 v[148:151], v196, s[44:47], s14 offen offset:2048 sc1
    buffer_load_dwordx4 v[152:155], v197, s[44:47], s14 offen offset:0 sc1
    buffer_load_dwordx4 v[156:159], v197, s[44:47], s14 offen offset:2048 sc1
    s_sleep 2
L_pp_6:
    buffer_load_dwordx4 v[160:163], v198, s[44:47], s15 offen offset:0 sc1
    buffer_load_dwordx4 v[164:167], v198, s[44:47], s15 offen offset:16 sc1
    buffer_load_dwordx4 v[168:171], v198, s[44:47], s15 offen offset:32 sc1
    buffer_load_dwordx4 v[172:175], v198, s[44:47], s15 offen offset:48 sc1
    buffer_load_dwordx4 v[128:131], v194, s[44:47], s14 offen offset:0 sc1
    buffer_load_dwordx4 v[132:135], v194, s[44:47], s14 offen offset:2048 sc1
    buffer_load_dwordx4 v[136:139], v195, s[44:47], s14 offen offset:0 sc1
    buffer_load_dwordx4 v[140:143], v195, s[44:47], s14 offen offset:2048 sc1
    buffer_load_dwordx4 v[144:147], v196, s[44:47], s14 offen offset:0 sc1
    buffer_load_dwordx4 v[148:151], v196, s[44:47], s14 offen offset:2048 sc1
    buffer_load_dwordx4 v[152:155], v197, s[44:47], s14 offen offset:0 sc1
    buffer_load_dwordx4 v[156:159], v197, s[44:47], s14 offen offset:2048 sc1
    s_waitcnt vmcnt(12)
    v_max3_u32 v8, v128, v129, v130
    v_max3_u32 v9, v131, v132, v133
    v_max3_u32 v8, v8, v134, v135
    v_max3_u32 v9, v9, v136, v137
    v_max3_u32 v8, v8, v138, v139
    v_max3_u32 v9, v9, v140, v141
    v_max3_u32 v8, v8, v142, v143
    v_max3_u32 v9, v9, v144, v145
    v_max3_u32 v8, v8, v146, v147
    v_max3_u32 v9, v9, v148, v149
    v_max3_u32 v8, v8, v150, v151
    v_max3_u32 v9, v9, v152, v153
    v_max3_u32 v8, v8, v154, v155
    v_max3_u32 v9, v9, v156, v157
    v_max3_u32 v8, v8, v158, v159
    v_max3_u32 v9, v9, v160, v161
    v_max3_u32 v8, v8, v162, v163
    v_max3_u32 v9, v9, v164, v165
    v_max3_u32 v8, v8, v166, v167
    v_max3_u32 v9, v9, v168, v169
    v_max3_u32 v8, v8, v170, v171
    v_max3_u32 v9, v9, v172, v173
    v_max3_u32 v8, v8, v174, v175
    v_max_u32 v8, v8, v9
    v_cmp_eq_u32 vcc, -1, v8
    s_cbranch_vccz L_hop_ok
    s_add_u32 s67, s67, 1
    s_cmp_lt_u32 s67, 262144
    s_cbranch_scc1 L_pp_6
L_hop_ok:
    v_max3_f32 v8, v160, v162, v164
    v_max3_f32 v9, v166, v168, v170
    v_max3_f32 v8, v8, v172, v174
    v_max_f32 v8, v8, v9
    v_sub_f32 v16, v160, v8
    v_sub_f32 v17, v162, v8
    v_sub_f32 v18, v164, v8
    v_sub_f32 v19, v166, v8
    v_sub_f32 v20, v168, v8
    v_sub_f32 v21, v170, v8
    v_sub_f32 v22, v172, v8
    v_sub_f32 v23, v174, v8
    v_exp_f32 v16, v16
    v_exp_f32 v17, v17
    v_exp_f32 v18, v18
    v_exp_f32 v19, v19
    v_exp_f32 v20, v20
    v_exp_f32 v21, v21
    v_exp_f32 v22, v22
    v_exp_f32 v23, v23
    v_mul_f32 v9, v16, v161
    v_fmac_f32 v9, v17, v163
    v_fmac_f32 v9, v18, v165
    v_fmac_f32 v9, v19, v167
    v_fmac_f32 v9, v20, v169
    v_fmac_f32 v9, v21, v171
    v_fmac_f32 v9, v22, v173
    v_fmac_f32 v9, v23, v175
    v_rcp_f32 v9, v9
    v_mul_f32 v24, v128, v16
    v_mul_f32 v25, v129, v16
    v_mul_f32 v26, v130, v16
    v_mul_f32 v27, v131, v16
    v_fmac_f32 v24, v132, v17
    v_fmac_f32 v25, v133, v17
    v_fmac_f32 v26, v134, v17
    v_fmac_f32 v27, v135, v17
    v_fmac_f32 v24, v136, v18
    v_fmac_f32 v25, v137, v18
    v_fmac_f32 v26, v138, v18
    v_fmac_f32 v27, v139, v18
    v_fmac_f32 v24, v140, v19
    v_fmac_f32 v25, v141, v19
    v_fmac_f32 v26, v142, v19
    v_fmac_f32 v27, v143, v19
    v_fmac_f32 v24, v144, v20
    v_fmac_f32 v25, v145, v20
    v_fmac_f32 v26, v146, v20
    v_fmac_f32 v27, v147, v20
    v_fmac_f32 v24, v148, v21
    v_fmac_f32 v25, v149, v21
    v_fmac_f32 v26, v150, v21
    v_fmac_f32 v27, v151, v21
    v_fmac_f32 v24, v152, v22
    v_fmac_f32 v25, v153, v22
    v_fmac_f32 v26, v154, v22
    v_fmac_f32 v27, v155, v22
    v_fmac_f32 v24, v156, v23
    v_fmac_f32 v25, v157, v23
    v_fmac_f32 v26, v158, v23
    v_fmac_f32 v27, v159, v23
    v_mul_f32 v24, v24, v9
    v_mul_f32 v25, v25, v9
    v_mul_f32 v26, v26, v9
    v_mul_f32 v27, v27, v9
    v_cvt_pk_bf16_f32 v8, v24, v25
    v_cvt_pk_bf16_f32 v9, v26, v27
    ds_write_b64 v199, v[8:9]
    s_waitcnt lgkmcnt(0)
    ds_read_b128 v[28:31], v192 offset:0
    ds_read_b128 v[32:35], v192 offset:64
    ds_read_b128 v[36:39], v192 offset:128
    ds_read_b128 v[40:43], v192 offset:192
    s_waitcnt lgkmcnt(3)
    v_mfma_f32_16x16x32_bf16 v[44:47], v[64:67], v[28:31], 0
    v_mfma_f32_16x16x32_bf16 v[48:51], v[68:71], v[28:31], 0
    v_mfma_f32_16x16x32_bf16 v[52:55], v[72:75], v[28:31], 0
    v_mfma_f32_16x16x32_bf16 v[56:59], v[76:79], v[28:31], 0
    s_waitcnt lgkmcnt(2)
    v_mfma_f32_16x16x32_bf16 v[44:47], v[80:83], v[32:35], v[44:47]
    v_mfma_f32_16x16x32_bf16 v[48:51], v[84:87], v[32:35], v[48:51]
    v_mfma_f32_16x16x32_bf16 v[52:55], v[88:91], v[32:35], v[52:55]
    v_mfma_f32_16x16x32_bf16 v[56:59], v[92:95], v[32:35], v[56:59]
    s_waitcnt lgkmcnt(1)
    v_mfma_f32_16x16x32_bf16 v[44:47], v[96:99], v[36:39], v[44:47]
    v_mfma_f32_16x16x32_bf16 v[48:51], v[100:103], v[36:39], v[48:51]
    v_mfma_f32_16x16x32_bf16 v[52:55], v[104:107], v[36:39], v[52:55]
    v_mfma_f32_16x16x32_bf16 v[56:59], v[108:111], v[36:39], v[56:59]
    s_waitcnt lgkmcnt(0)
    v_mfma_f32_16x16x32_bf16 v[44:47], v[112:115], v[40:43], v[44:47]
    v_mfma_f32_16x16x32_bf16 v[48:51], v[116:119], v[40:43], v[48:51]
    v_mfma_f32_16x16x32_bf16 v[52:55], v[120:123], v[40:43], v[52:55]
    v_mfma_f32_16x16x32_bf16 v[56:59], v[124:127], v[40:43], v[56:59]
    s_nop 5
    v_cndmask_b32 v44, v44, v48, s[76:77]
    s_nop 0
    v_cndmask_b32 v52, v52, v56, s[76:77]
    v_cndmask_b32 v45, v45, v49, s[76:77]
    v_cndmask_b32 v53, v53, v57, s[76:77]
    v_cndmask_b32 v46, v46, v50, s[76:77]
    v_cndmask_b32 v54, v54, v58, s[76:77]
    v_cndmask_b32 v47, v47, v51, s[76:77]
    v_cndmask_b32 v55, v55, v59, s[76:77]
    v_cndmask_b32 v44, v44, v52, s[78:79]
    v_cndmask_b32 v45, v45, v53, s[78:79]
    v_cndmask_b32 v46, v46, v54, s[78:79]
    v_cndmask_b32 v47, v47, v55, s[78:79]
    v_min_u32 v44, -2, v44
    v_min_u32 v45, -2, v45
    v_min_u32 v46, -2, v46
    v_min_u32 v47, -2, v47
    s_mov_b32 exec_lo, 0xff00ff
    s_mov_b32 exec_hi, 0xff00ff
    buffer_store_dwordx4 v[44:47], v191, s[44:47], s58 offen sc1
    s_mov_b64 exec, -1
M_svend:
    s_endpgm
M_wd:
    s_waitcnt vmcnt(0)
    ds_write_b128 v2, v[64:67] offset:0
    ds_write_b128 v2, v[68:71] offset:1024
    ds_write_b128 v2, v[72:75] offset:2048
    ds_write_b128 v2, v[76:79] offset:3072
    ds_write_b128 v2, v[80:83] offset:4096
    ds_write_b128 v2, v[84:87] offset:5120
    ds_write_b128 v2, v[88:91] offset:6144
    ds_write_b128 v2, v[92:95] offset:7168
    ds_write_b128 v2, v[96:99] offset:8192
    ds_write_b128 v2, v[100:103] offset:9216
    ds_write_b128 v2, v[104:107] offset:10240
    ds_write_b128 v2, v[108:111] offset:11264
    ds_write_b128 v2, v[112:115] offset:12288
    ds_write_b128 v2, v[116:119] offset:13312
    ds_write_b128 v2, v[120:123] offset:14336
    ds_write_b128 v2, v[124:127] offset:15360
    ds_write_b128 v2, v[128:131] offset:16384
    ds_write_b128 v2, v[132:135] offset:17408
    ds_write_b128 v2, v[136:139] offset:18432
    ds_write_b128 v2, v[140:143] offset:19456
    ds_write_b128 v2, v[144:147] offset:20480
    ds_write_b128 v2, v[148:151] offset:21504
    ds_write_b128 v2, v[152:155] offset:22528
    ds_write_b128 v2, v[156:159] offset:23552
    s_waitcnt lgkmcnt(0)
    ds_read_b64_tr_b16 v[64:65], v3 offset:0
    ds_read_b64_tr_b16 v[66:67], v3 offset:512
    ds_read_b64_tr_b16 v[68:69], v3 offset:32
    ds_read_b64_tr_b16 v[70:71], v3 offset:544
    ds_read_b64_tr_b16 v[72:73], v3 offset:64
    ds_read_b64_tr_b16 v[74:75], v3 offset:576
    ds_read_b64_tr_b16 v[76:77], v3 offset:96
    ds_read_b64_tr_b16 v[78:79], v3 offset:608
    ds_read_b64_tr_b16 v[80:81], v3 offset:4096
    ds_read_b64_tr_b16 v[82:83], v3 offset:4608
    ds_read_b64_tr_b16 v[84:85], v3 offset:4128
    ds_read_b64_tr_b16 v[86:87], v3 offset:4640
    ds_read_b64_tr_b16 v[88:89], v3 offset:4160
    ds_read_b64_tr_b16 v[90:91], v3 offset:4672
    ds_read_b64_tr_b16 v[92:93], v3 offset:4192
    ds_read_b64_tr_b16 v[94:95], v3 offset:4704
    ds_read_b64_tr_b16 v[96:97], v3 offset:8192
    ds_read_b64_tr_b16 v[98:99], v3 offset:8704
    ds_read_b64_tr_b16 v[100:101], v3 offset:8224
    ds_read_b64_tr_b16 v[102:103], v3 offset:8736
    ds_read_b64_tr_b16 v[104:105], v3 offset:8256
    ds_read_b64_tr_b16 v[106:107], v3 offset:8768
    ds_read_b64_tr_b16 v[108:109], v3 offset:8288
    ds_read_b64_tr_b16 v[110:111], v3 offset:8800
    ds_read_b64_tr_b16 v[112:113], v3 offset:12288
    ds_read_b64_tr_b16 v[114:115], v3 offset:12800
    ds_read_b64_tr_b16 v[116:117], v3 offset:12320
    ds_read_b64_tr_b16 v[118:119], v3 offset:12832
    ds_read_b64_tr_b16 v[120:121], v3 offset:12352
    ds_read_b64_tr_b16 v[122:123], v3 offset:12864
    ds_read_b64_tr_b16 v[124:125], v3 offset:12384
    ds_read_b64_tr_b16 v[126:127], v3 offset:12896
    ds_read_b64_tr_b16 v[128:129], v3 offset:16384
    ds_read_b64_tr_b16 v[130:131], v3 offset:16896
    ds_read_b64_tr_b16 v[132:133], v3 offset:16416
    ds_read_b64_tr_b16 v[134:135], v3 offset:16928
    ds_read_b64_tr_b16 v[136:137], v3 offset:16448
    ds_read_b64_tr_b16 v[138:139], v3 offset:16960
    ds_read_b64_tr_b16 v[140:141], v3 offset:16480
    ds_read_b64_tr_b16 v[142:143], v3 offset:16992
    ds_read_b64_tr_b16 v[144:145], v3 offset:20480
    ds_read_b64_tr_b16 v[146:147], v3 offset:20992
    ds_read_b64_tr_b16 v[148:149], v3 offset:20512
    ds_read_b64_tr_b16 v[150:151], v3 offset:21024
    ds_read_b64_tr_b16 v[152:153], v3 offset:20544
    ds_read_b64_tr_b16 v[154:155], v3 offset:21056
    ds_read_b64_tr_b16 v[156:157], v3 offset:20576
    ds_read_b64_tr_b16 v[158:159], v3 offset:21088
    s_waitcnt lgkmcnt(0)
    v_mfma_f32_16x16x32_bf16 v[16:19], v[64:67], v[200:203], 0
    v_mfma_f32_16x16x32_bf16 v[20:23], v[68:71], v[200:203], 0
    v_mfma_f32_16x16x32_bf16 v[24:27], v[72:75], v[200:203], 0
    v_mfma_f32_16x16x32_bf16 v[28:31], v[76:79], v[200:203], 0
    v_mfma_f32_16x16x32_bf16 v[16:19], v[80:83], v[204:207], v[16:19]
    v_mfma_f32_16x16x32_bf16 v[20:23], v[84:87], v[204:207], v[20:23]
    v_mfma_f32_16x16x32_bf16 v[24:27], v[88:91], v[204:207], v[24:27]
    v_mfma_f32_16x16x32_bf16 v[28:31], v[92:95], v[204:207], v[28:31]
    v_mfma_f32_16x16x32_bf16 v[16:19], v[96:99], v[208:211], v[16:19]
    v_mfma_f32_16x16x32_bf16 v[20:23], v[100:103], v[208:211], v[20:23]
    v_mfma_f32_16x16x32_bf16 v[24:27], v[104:107], v[208:211], v[24:27]
    v_mfma_f32_16x16x32_bf16 v[28:31], v[108:111], v[208:211], v[28:31]
    v_mfma_f32_16x16x32_bf16 v[16:19], v[112:115], v[212:215], v[16:19]
    v_mfma_f32_16x16x32_bf16 v[20:23], v[116:119], v[212:215], v[20:23]
    v_mfma_f32_16x16x32_bf16 v[24:27], v[120:123], v[212:215], v[24:27]
    v_mfma_f32_16x16x32_bf16 v[28:31], v[124:127], v[212:215], v[28:31]
    v_mfma_f32_16x16x32_bf16 v[16:19], v[128:131], v[216:219], v[16:19]
    v_mfma_f32_16x16x32_bf16 v[20:23], v[132:135], v[216:219], v[20:23]
    v_mfma_f32_16x16x32_bf16 v[24:27], v[136:139], v[216:219], v[24:27]
    v_mfma_f32_16x16x32_bf16 v[28:31], v[140:143], v[216:219], v[28:31]
    v_mfma_f32_16x16x32_bf16 v[16:19], v[144:147], v[220:223], v[16:19]
    v_mfma_f32_16x16x32_bf16 v[20:23], v[148:151], v[220:223], v[20:23]
    v_mfma_f32_16x16x32_bf16 v[24:27], v[152:155], v[220:223], v[24:27]
    v_mfma_f32_16x16x32_bf16 v[28:31], v[156:159], v[220:223], v[28:31]
    s_nop 5
    v_cndmask_b32 v16, v16, v20, s[76:77]
    s_nop 0
    v_cndmask_b32 v24, v24, v28, s[76:77]
    v_cndmask_b32 v17, v17, v21, s[76:77]
    v_cndmask_b32 v25, v25, v29, s[76:77]
    v_cndmask_b32 v18, v18, v22, s[76:77]
    v_cndmask_b32 v26, v26, v30, s[76:77]
    v_cndmask_b32 v19, v19, v23, s[76:77]
    v_cndmask_b32 v27, v27, v31, s[76:77]
    v_cndmask_b32 v16, v16, v24, s[78:79]
    v_cndmask_b32 v17, v17, v25, s[78:79]
    v_cndmask_b32 v18, v18, v26, s[78:79]
    v_cndmask_b32 v19, v19, v27, s[78:79]
    v_min_u32 v16, -2, v16
    v_min_u32 v17, -2, v17
    v_min_u32 v18, -2, v18
    v_min_u32 v19, -2, v19
    s_mov_b32 exec_lo, 0xff00ff
    s_mov_b32 exec_hi, 0xff00ff
    buffer_store_dwordx4 v[16:19], v191, s[44:47], s58 offen sc1
    s_mov_b64 exec, -1
    s_branch M_svend
M_w1:
    v_lshlrev_b32 v62, 4, v1
    v_mov_b32 v20, -1
    v_mov_b32 v21, -1
    v_mov_b32 v22, -1
    v_mov_b32 v23, -1
    s_lshl_b32 s62, s2, 11
    s_add_u32 s62, s62, 1048576
    buffer_store_dwordx4 v[20:23], v62, s[44:47], s62 offen sc1
    buffer_store_dwordx4 v[20:23], v62, s[44:47], s62 offen offset:1024 sc1
    s_and_b32 s60, s2, 15
    s_cmp_lg_u32 s60, 1
    s_cbranch_scc1 L_c1
    s_lshl_b32 s62, s4, 8
    s_add_u32 s62, s62, 262144
    s_mov_b64 exec, 0xffff
    buffer_store_dwordx4 v[20:23], v62, s[44:47], s62 offen sc1
    s_mov_b64 exec, -1
L_c1:
    s_cmp_lg_u32 s6, 0
    s_cbranch_scc1 L_c2
    v_mov_b32 v24, 0
    v_mov_b32 v25, 0
    v_mov_b32 v26, 0
    v_mov_b32 v27, 0
    s_mul_i32 s62, s7, 4352
    s_add_u32 s62, s62, 524288
    s_mov_b64 exec, 15
    buffer_store_dwordx4 v[24:27], v62, s[44:47], s62 offen sc1
    s_mov_b64 exec, -1
L_c2:
    s_bitcmp1_b32 s27, 0
    s_cbranch_scc0 M_w1a
    s_mov_b32 s40, s28
    s_mov_b32 s41, s29
    s_mov_b32 s42, 0x510000
    s_mov_b32 s43, 0x20000
    s_mov_b32 s48, s30
    s_mov_b32 s49, s31
    s_mov_b32 s50, 0x510000
    s_mov_b32 s51, 0x20000
    s_mov_b32 s62, 9216
    v_lshrrev_b32 v56, 3, v1
    v_mul_lo_u32 v56, v56, s62
    v_and_b32 v7, 7, v1
    v_lshl_add_u32 v56, v7, 4, v56
    s_mul_i32 s61, s62, 64
    v_add_u32 v57, s61, v56
    v_add_u32 v58, s61, v57
    s_lshl_b32 s68, s59, 7
    s_add_u32 s69, s68, 73728
    s_add_u32 s70, s69, 73728
    s_add_u32 s71, s70, 73728
    s_add_u32 s72, s71, 73728
    s_add_u32 s73, s72, 73728
    s_add_u32 s74, s73, 73728
    s_add_u32 s75, s74, 73728
    s_call_b64 s[82:83], F_ld
    v_and_b32 v6, 1, v1
    v_mul_u32_u24 v6, 1152, v6
    v_add_u32 v6, v6, v4
    v_mov_b32 v16, 0
    v_mov_b32 v17, 0
    v_mov_b32 v18, 0
    v_mov_b32 v19, 0
    v_mov_b32 v20, 0
    v_mov_b32 v21, 0
    v_mov_b32 v22, 0
    v_mov_b32 v23, 0
    v_mov_b32 v24, 0
    v_mov_b32 v25, 0
    v_mov_b32 v26, 0
    v_mov_b32 v27, 0
    v_mov_b32 v28, 0
    v_mov_b32 v29, 0
    v_mov_b32 v30, 0
    v_mov_b32 v31, 0
    v_mov_b32 v32, 0
    v_mov_b32 v33, 0
    v_mov_b32 v34, 0
    v_mov_b32 v35, 0
    v_mov_b32 v36, 0
    v_mov_b32 v37, 0
    v_mov_b32 v38, 0
    v_mov_b32 v39, 0
    v_mov_b32 v40, 0
    v_mov_b32 v41, 0
    v_mov_b32 v42, 0
    v_mov_b32 v43, 0
    v_mov_b32 v44, 0
    v_mov_b32 v45, 0
    v_mov_b32 v46, 0
    v_mov_b32 v47, 0
    v_mov_b32 v9, 2064
    s_mov_b32 s67, 0
L_fw_7:
    ds_read_b32 v8, v9
    s_waitcnt lgkmcnt(0)
    v_readfirstlane_b32 s60, v8
    s_cmp_ge_u32 s60, 1
    s_cbranch_scc1 L_fw_7_ok
    s_sleep 4
    s_add_u32 s67, s67, 1
    s_cmp_lt_u32 s67, 4194304
    s_cbranch_scc1 L_fw_7
L_fw_7_ok:
    v_mov_b32 v9, 2048
    ds_read_b64 v[10:11], v9 offset:8
    s_waitcnt lgkmcnt(0)
    v_readfirstlane_b32 s12, v10
    v_readfirstlane_b32 s13, v11
    s_waitcnt vmcnt(0)
    v_mov_b32 v8, 0
    v_mov_b32 v9, s12
    v_mov_b32 v10, 0
    v_mov_b32 v11, s13
    v_mov_b32 v12, 0
    s_lshl_b32 s60, s2, 4
    s_add_u32 s60, s60, 327680
    s_mov_b64 exec, 1
    buffer_store_dwordx4 v[8:11], v12, s[44:47], s60 offen sc1
    s_mov_b64 exec, -1
    s_mov_b32 s62, 0
L_rnd:
    s_waitcnt vmcnt(0)
    ds_write_b128 v2, v[64:67] offset:0
    ds_write_b128 v2, v[68:71] offset:1024
    ds_write_b128 v2, v[72:75] offset:2048
    ds_write_b128 v2, v[76:79] offset:3072
    ds_write_b128 v2, v[80:83] offset:4096
    ds_write_b128 v2, v[84:87] offset:5120
    ds_write_b128 v2, v[88:91] offset:6144
    ds_write_b128 v2, v[92:95] offset:7168
    ds_write_b128 v2, v[96:99] offset:8192
    ds_write_b128 v2, v[100:103] offset:9216
    ds_write_b128 v2, v[104:107] offset:10240
    ds_write_b128 v2, v[108:111] offset:11264
    ds_write_b128 v2, v[112:115] offset:12288
    ds_write_b128 v2, v[116:119] offset:13312
    ds_write_b128 v2, v[120:123] offset:14336
    ds_write_b128 v2, v[124:127] offset:15360
    ds_write_b128 v2, v[128:131] offset:16384
    ds_write_b128 v2, v[132:135] offset:17408
    ds_write_b128 v2, v[136:139] offset:18432
    ds_write_b128 v2, v[140:143] offset:19456
    ds_write_b128 v2, v[144:147] offset:20480
    ds_write_b128 v2, v[148:151] offset:21504
    ds_write_b128 v2, v[152:155] offset:22528
    ds_write_b128 v2, v[156:159] offset:23552
    ds_write_b128 v2, v[160:163] offset:24576
    ds_write_b128 v2, v[164:167] offset:25600
    ds_write_b128 v2, v[168:171] offset:26624
    ds_write_b128 v2, v[172:175] offset:27648
    ds_write_b128 v2, v[176:179] offset:28672
    ds_write_b128 v2, v[180:183] offset:29696
    ds_write_b128 v2, v[184:187] offset:30720
    ds_write_b128 v2, v[188:191] offset:31744
    ds_write_b128 v2, v[192:195] offset:32768
    ds_write_b128 v2, v[196:199] offset:33792
    ds_write_b128 v2, v[200:203] offset:34816
    ds_write_b128 v2, v[204:207] offset:35840
    ds_write_b128 v2, v[208:211] offset:36864
    ds_write_b128 v2, v[212:215] offset:37888
    ds_write_b128 v2, v[216:219] offset:38912
    ds_write_b128 v2, v[220:223] offset:39936
    ds_write_b128 v2, v[224:227] offset:40960
    ds_write_b128 v2, v[228:231] offset:41984
    ds_write_b128 v2, v[232:235] offset:43008
    ds_write_b128 v2, v[236:239] offset:44032
    ds_write_b128 v2, v[240:243] offset:45056
    ds_write_b128 v2, v[244:247] offset:46080
    ds_write_b128 v2, v[248:251] offset:47104
    ds_write_b128 v2, v[252:255] offset:48128
    s_waitcnt lgkmcnt(0)
    s_cmp_eq_u32 s62, 2
    s_cbranch_scc1 L_rnd2
    s_call_b64 s[82:83], F_ld
L_rnd2:
    v_mov_b32 v59, v3
    s_mov_b32 s63, 0
L_stp:
    ds_read_b128 v[8:11], v6 offset:2304
    ds_read_b64_tr_b16 v[48:49], v59 offset:0
    ds_read_b64_tr_b16 v[50:51], v59 offset:512
    ds_read_b64_tr_b16 v[52:53], v59 offset:32
    ds_read_b64_tr_b16 v[54:55], v59 offset:544
    ds_read_b64_tr_b16 v[60:61], v59 offset:64
    ds_read_b64_tr_b16 v[62:63], v59 offset:576
    ds_read_b64_tr_b16 v[12:13], v59 offset:96
    ds_read_b64_tr_b16 v[14:15], v59 offset:608
    s_waitcnt lgkmcnt(0)
    v_mfma_f32_16x16x32_bf16 v[16:19], v[48:51], v[8:11], v[16:19]
    v_mfma_f32_16x16x32_bf16 v[20:23], v[52:55], v[8:11], v[20:23]
    v_mfma_f32_16x16x32_bf16 v[24:27], v[60:63], v[8:11], v[24:27]
    v_mfma_f32_16x16x32_bf16 v[28:31], v[12:15], v[8:11], v[28:31]
    ds_read_b64_tr_b16 v[48:49], v59 offset:24576
    ds_read_b64_tr_b16 v[50:51], v59 offset:25088
    ds_read_b64_tr_b16 v[52:53], v59 offset:24608
    ds_read_b64_tr_b16 v[54:55], v59 offset:25120
    ds_read_b64_tr_b16 v[60:61], v59 offset:24640
    ds_read_b64_tr_b16 v[62:63], v59 offset:25152
    ds_read_b64_tr_b16 v[12:13], v59 offset:24672
    ds_read_b64_tr_b16 v[14:15], v59 offset:25184
    s_waitcnt lgkmcnt(0)
    v_mfma_f32_16x16x32_bf16 v[32:35], v[48:51], v[8:11], v[32:35]
    v_mfma_f32_16x16x32_bf16 v[36:39], v[52:55], v[8:11], v[36:39]
    v_mfma_f32_16x16x32_bf16 v[40:43], v[60:63], v[8:11], v[40:43]
    v_mfma_f32_16x16x32_bf16 v[44:47], v[12:15], v[8:11], v[44:47]
    v_add_u32 v59, 4096, v59
    v_add_u32 v6, 64, v6
    s_add_u32 s63, s63, 1
    s_cmp_lt_u32 s63, 6
    s_cbranch_scc1 L_stp
    s_add_u32 s62, s62, 1
    s_cmp_lt_u32 s62, 3
    s_cbranch_scc1 L_rnd
    s_nop 7
    v_cndmask_b32 v16, v16, v20, s[76:77]
    v_cndmask_b32 v24, v24, v28, s[76:77]
    v_cndmask_b32 v17, v17, v21, s[76:77]
    v_cndmask_b32 v25, v25, v29, s[76:77]
    v_cndmask_b32 v18, v18, v22, s[76:77]
    v_cndmask_b32 v26, v26, v30, s[76:77]
    v_cndmask_b32 v19, v19, v23, s[76:77]
    v_cndmask_b32 v27, v27, v31, s[76:77]
    v_cndmask_b32 v48, v16, v24, s[78:79]
    v_cndmask_b32 v49, v17, v25, s[78:79]
    v_cndmask_b32 v50, v18, v26, s[78:79]
    v_cndmask_b32 v51, v19, v27, s[78:79]
    v_cndmask_b32 v32, v32, v36, s[76:77]
    v_cndmask_b32 v40, v40, v44, s[76:77]
    v_cndmask_b32 v33, v33, v37, s[76:77]
    v_cndmask_b32 v41, v41, v45, s[76:77]
    v_cndmask_b32 v34, v34, v38, s[76:77]
    v_cndmask_b32 v42, v42, v46, s[76:77]
    v_cndmask_b32 v35, v35, v39, s[76:77]
    v_cndmask_b32 v43, v43, v47, s[76:77]
    v_cndmask_b32 v52, v32, v40, s[78:79]
    v_cndmask_b32 v53, v33, v41, s[78:79]
    v_cndmask_b32 v54, v34, v42, s[78:79]
    v_cndmask_b32 v55, v35, v43, s[78:79]
    v_cvt_pk_bf16_f32 v8, v48, v52
    v_lshlrev_b32 v48, 16, v8
    v_and_b32 v52, 0xffff0000, v8
    v_cvt_pk_bf16_f32 v9, v49, v53
    v_lshlrev_b32 v49, 16, v9
    v_and_b32 v53, 0xffff0000, v9
    v_cvt_pk_bf16_f32 v8, v50, v54
    v_lshlrev_b32 v50, 16, v8
    v_and_b32 v54, 0xffff0000, v8
    v_cvt_pk_bf16_f32 v9, v51, v55
    v_lshlrev_b32 v51, 16, v9
    v_and_b32 v55, 0xffff0000, v9
    v_mul_f32 v60, s11, v48
    v_mul_f32 v61, s11, v49
    v_mul_f32 v62, s11, v50
    v_mul_f32 v63, s11, v51
    v_exp_f32 v60, -v60
    v_exp_f32 v61, -v61
    v_exp_f32 v62, -v62
    v_exp_f32 v63, -v63
    v_add_f32 v60, 1.0, v60
    v_add_f32 v61, 1.0, v61
    v_add_f32 v62, 1.0, v62
    v_add_f32 v63, 1.0, v63
    v_rcp_f32 v60, v60
    v_rcp_f32 v61, v61
    v_rcp_f32 v62, v62
    v_rcp_f32 v63, v63
    v_mul_f32 v48, v48, v60
    v_mul_f32 v49, v49, v61
    v_mul_f32 v50, v50, v62
    v_mul_f32 v51, v51, v63
    v_cvt_pk_bf16_f32 v8, v48, v49
    v_lshlrev_b32 v48, 16, v8
    v_and_b32 v49, 0xffff0000, v8
    v_cvt_pk_bf16_f32 v9, v50, v51
    v_lshlrev_b32 v50, 16, v9
    v_and_b32 v51, 0xffff0000, v9
    v_mul_f32 v48, v48, v52
    v_mul_f32 v49, v49, v53
    v_mul_f32 v50, v50, v54
    v_mul_f32 v51, v51, v55
    v_cvt_pk_bf16_f32 v60, v48, v49
    v_cvt_pk_bf16_f32 v62, v50, v51
    v_xor_b32 v61, s12, v62
    v_xor_b32 v63, s13, v60
    v_and_b32 v13, 1, v1
    v_mul_u32_u24 v13, 18432, v13
    v_lshl_add_u32 v13, v5, 4, v13
    s_lshl_b32 s60, s59, 8
    s_add_u32 s60, s60, 196608
    s_mov_b32 exec_lo, 0xff00ff
    s_mov_b32 exec_hi, 0xff00ff
    buffer_store_dwordx4 v[60:63], v13, s[44:47], s60 offen sc1
    s_mov_b64 exec, -1
    s_branch M_w1b
M_w1a:
    v_mov_b32 v9, 2064
    s_mov_b32 s67, 0
L_fw_8:
    ds_read_b32 v8, v9
    s_waitcnt lgkmcnt(0)
    v_readfirstlane_b32 s60, v8
    s_cmp_ge_u32 s60, 1
    s_cbranch_scc1 L_fw_8_ok
    s_sleep 4
    s_add_u32 s67, s67, 1
    s_cmp_lt_u32 s67, 4194304
    s_cbranch_scc1 L_fw_8
L_fw_8_ok:
    v_mov_b32 v9, 2048
    ds_read_b64 v[10:11], v9 offset:8
    s_waitcnt lgkmcnt(0)
    v_readfirstlane_b32 s12, v10
    v_readfirstlane_b32 s13, v11
    s_waitcnt vmcnt(0)
    v_mov_b32 v8, 0
    v_mov_b32 v9, s12
    v_mov_b32 v10, 0
    v_mov_b32 v11, s13
    v_mov_b32 v12, 0
    s_lshl_b32 s60, s2, 4
    s_add_u32 s60, s60, 327680
    s_mov_b64 exec, 1
    buffer_store_dwordx4 v[8:11], v12, s[44:47], s60 offen sc1
    s_mov_b64 exec, -1
M_w1b:
    s_cmp_eq_u32 s9, 2
    s_cbranch_scc1 M_svend
    s_call_b64 s[82:83], F_tp
    v_mov_b32 v9, 2072
    s_mov_b32 s67, 0
L_fw_9:
    ds_read_b32 v8, v9
    s_waitcnt lgkmcnt(0)
    v_readfirstlane_b32 s60, v8
    s_cmp_ge_u32 s60, 1
    s_cbranch_scc1 L_fw_9_ok
    s_sleep 4
    s_add_u32 s67, s67, 1
    s_cmp_lt_u32 s67, 4194304
    s_cbranch_scc1 L_fw_9
L_fw_9_ok:
    s_call_b64 s[82:83], F_tl
    s_branch M_tail
F_ld:
    buffer_load_dwordx4 v[64:67], v56, s[40:43], s68 offen nt
    buffer_load_dwordx4 v[68:71], v56, s[40:43], s69 offen nt
    buffer_load_dwordx4 v[72:75], v56, s[40:43], s70 offen nt
    buffer_load_dwordx4 v[76:79], v56, s[40:43], s71 offen nt
    buffer_load_dwordx4 v[80:83], v56, s[40:43], s72 offen nt
    buffer_load_dwordx4 v[84:87], v56, s[40:43], s73 offen nt
    buffer_load_dwordx4 v[88:91], v56, s[40:43], s74 offen nt
    buffer_load_dwordx4 v[92:95], v56, s[40:43], s75 offen nt
    buffer_load_dwordx4 v[96:99], v57, s[40:43], s68 offen nt
    buffer_load_dwordx4 v[100:103], v57, s[40:43], s69 offen nt
    buffer_load_dwordx4 v[104:107], v57, s[40:43], s70 offen nt
    buffer_load_dwordx4 v[108:111], v57, s[40:43], s71 offen nt
    buffer_load_dwordx4 v[112:115], v57, s[40:43], s72 offen nt
    buffer_load_dwordx4 v[116:119], v57, s[40:43], s73 offen nt
    buffer_load_dwordx4 v[120:123], v57, s[40:43], s74 offen nt
    buffer_load_dwordx4 v[124:127], v57, s[40:43], s75 offen nt
    buffer_load_dwordx4 v[128:131], v58, s[40:43], s68 offen nt
    buffer_load_dwordx4 v[132:135], v58, s[40:43], s69 offen nt
    buffer_load_dwordx4 v[136:139], v58, s[40:43], s70 offen nt
    buffer_load_dwordx4 v[140:143], v58, s[40:43], s71 offen nt
    buffer_load_dwordx4 v[144:147], v58, s[40:43], s72 offen nt
    buffer_load_dwordx4 v[148:151], v58, s[40:43], s73 offen nt
    buffer_load_dwordx4 v[152:155], v58, s[40:43], s74 offen nt
    buffer_load_dwordx4 v[156:159], v58, s[40:43], s75 offen nt
    buffer_load_dwordx4 v[160:163], v56, s[48:51], s68 offen nt
    buffer_load_dwordx4 v[164:167], v56, s[48:51], s69 offen nt
    buffer_load_dwordx4 v[168:171], v56, s[48:51], s70 offen nt
    buffer_load_dwordx4 v[172:175], v56, s[48:51], s71 offen nt
    buffer_load_dwordx4 v[176:179], v56, s[48:51], s72 offen nt
    buffer_load_dwordx4 v[180:183], v56, s[48:51], s73 offen nt
    buffer_load_dwordx4 v[184:187], v56, s[48:51], s74 offen nt
    buffer_load_dwordx4 v[188:191], v56, s[48:51], s75 offen nt
    buffer_load_dwordx4 v[192:195], v57, s[48:51], s68 offen nt
    buffer_load_dwordx4 v[196:199], v57, s[48:51], s69 offen nt
    buffer_load_dwordx4 v[200:203], v57, s[48:51], s70 offen nt
    buffer_load_dwordx4 v[204:207], v57, s[48:51], s71 offen nt
    buffer_load_dwordx4 v[208:211], v57, s[48:51], s72 offen nt
    buffer_load_dwordx4 v[212:215], v57, s[48:51], s73 offen nt
    buffer_load_dwordx4 v[216:219], v57, s[48:51], s74 offen nt
    buffer_load_dwordx4 v[220:223], v57, s[48:51], s75 offen nt
    buffer_load_dwordx4 v[224:227], v58, s[48:51], s68 offen nt
    buffer_load_dwordx4 v[228:231], v58, s[48:51], s69 offen nt
    buffer_load_dwordx4 v[232:235], v58, s[48:51], s70 offen nt
    buffer_load_dwordx4 v[236:239], v58, s[48:51], s71 offen nt
    buffer_load_dwordx4 v[240:243], v58, s[48:51], s72 offen nt
    buffer_load_dwordx4 v[244:247], v58, s[48:51], s73 offen nt
    buffer_load_dwordx4 v[248:251], v58, s[48:51], s74 offen nt
    buffer_load_dwordx4 v[252:255], v58, s[48:51], s75 offen nt
    v_add_u32 v56, 0x1b0000, v56
    v_add_u32 v57, 0x1b0000, v57
    v_add_u32 v58, 0x1b0000, v58
    s_setpc_b64 s[82:83]
F_tp:
    s_mov_b32 s62, 1152
    v_lshrrev_b32 v56, 3, v1
    v_mul_lo_u32 v56, v56, s62
    v_and_b32 v7, 7, v1
    v_lshl_add_u32 v56, v7, 4, v56
    s_mul_i32 s61, s62, 64
    v_add_u32 v57, s61, v56
    v_add_u32 v58, s61, v57
    v_and_b32 v14, 1, v1
    v_lshl_add_u32 v193, v14, 8, v4
    v_lshlrev_b32 v191, 8, v14
    v_lshl_add_u32 v191, v5, 4, v191
    s_lshl_b32 s58, s2, 11
    s_lshl_b32 s60, s3, 9
    s_add_u32 s58, s58, s60
    s_add_u32 s58, s58, 1049600
    v_lshrrev_b32 v194, 5, v1
    v_lshlrev_b32 v198, 6, v194
    v_lshlrev_b32 v194, 14, v194
    v_and_b32 v7, 31, v1
    v_lshl_add_u32 v194, v7, 4, v194
    v_add_u32 v195, 4096, v194
    v_add_u32 v196, 8192, v194
    v_add_u32 v197, 12288, v194
    s_lshl_b32 s66, s26, 7
    s_cmp_lg_u32 s9, 0
    s_cbranch_scc1 F_tp_wd
    s_mov_b32 s40, s24
    s_mov_b32 s41, s25
    s_mov_b32 s42, 0x480000
    s_mov_b32 s43, 0x20000
    s_lshl_b32 s60, s56, 3
    s_add_u32 s60, s60, s6
    s_mul_i32 s61, s60, 147456
    s_add_u32 s68, s61, s66
    s_lshr_b32 s14, s60, 1
    s_lshl_b32 s14, s14, 15
    s_and_b32 s61, s60, 1
    s_lshl_b32 s61, s61, 9
    s_add_u32 s14, s14, s61
    s_add_u32 s14, s14, 1048576
    s_lshl_b32 s15, s60, 7
    s_add_u32 s15, s15, 262144
    s_lshl_b32 s60, s3, 9
    s_add_u32 s60, s60, 7424
    v_lshl_add_u32 v199, v1, 3, s60
    v_add_u32 v192, s60, v193
    s_branch F_tp_end
F_tp_wd:
    s_mov_b32 s40, s32
    s_mov_b32 s41, s33
    s_mov_b32 s42, 0x510000
    s_mov_b32 s43, 0x20000
    s_mul_i32 s60, s6, 3
    s_add_u32 s60, s60, s56
    s_sub_u32 s60, s60, 4
    s_mul_i32 s61, s60, 221184
    s_add_u32 s68, s61, s66
    s_mul_i32 s60, s60, 768
    s_add_u32 s60, s60, 196608
    s_add_u32 s61, s60, 18432
    v_lshlrev_b32 v12, 4, v1
    s_mov_b32 exec_lo, 0xffffffff
    s_mov_b32 exec_hi, 0xffff
    s_mov_b32 s67, 0
L_pl_10:
    buffer_load_dwordx4 v[28:31], v12, s[44:47], s60 offen sc1
    buffer_load_dwordx4 v[32:35], v12, s[44:47], s61 offen sc1
    s_waitcnt vmcnt(0)
    v_bitop3_b32 v9, v29, v30, s12 bitop3:0x96
    v_bitop3_b32 v10, v31, v28, s13 bitop3:0x96
    v_or_b32 v8, v9, v10
    v_bitop3_b32 v9, v33, v34, s12 bitop3:0x96
    v_bitop3_b32 v10, v35, v32, s13 bitop3:0x96
    v_or3_b32 v8, v8, v9, v10
    v_cmp_ne_u32 vcc, 0, v8
    s_cbranch_vccz L_pl_10_ok
    s_sleep 100
    s_add_u32 s67, s67, 1
    s_cmp_lt_u32 s67, 262144
    s_cbranch_scc1 L_pl_10
L_pl_10_ok:
    s_mul_i32 s60, s3, 768
    s_add_u32 s60, s60, 4608
    v_lshl_add_u32 v12, v1, 3, s60
    v_mov_b32 v29, v30
    v_mov_b32 v33, v34
    ds_write_b64 v12, v[28:29]
    ds_write_b64 v12, v[32:33] offset:384
    s_mov_b64 exec, -1
    v_mul_u32_u24 v12, 384, v14
    v_add3_u32 v12, v12, v4, s60
    s_waitcnt lgkmcnt(0)
    ds_read_b128 v[200:203], v12 offset:0
    ds_read_b128 v[204:207], v12 offset:64
    ds_read_b128 v[208:211], v12 offset:128
    ds_read_b128 v[212:215], v12 offset:192
    ds_read_b128 v[216:219], v12 offset:256
    ds_read_b128 v[220:223], v12 offset:320
    s_waitcnt lgkmcnt(0)
F_tp_end:
    s_add_u32 s69, s68, 9216
    s_add_u32 s70, s69, 9216
    s_add_u32 s71, s70, 9216
    s_add_u32 s72, s71, 9216
    s_add_u32 s73, s72, 9216
    s_add_u32 s74, s73, 9216
    s_add_u32 s75, s74, 9216
    s_setpc_b64 s[82:83]
F_tl:
    s_setprio 0
    buffer_load_dwordx4 v[64:67], v56, s[40:43], s68 offen nt
    buffer_load_dwordx4 v[68:71], v56, s[40:43], s69 offen nt
    buffer_load_dwordx4 v[72:75], v56, s[40:43], s70 offen nt
    buffer_load_dwordx4 v[76:79], v56, s[40:43], s71 offen nt
    buffer_load_dwordx4 v[80:83], v56, s[40:43], s72 offen nt
    buffer_load_dwordx4 v[84:87], v56, s[40:43], s73 offen nt
    buffer_load_dwordx4 v[88:91], v56, s[40:43], s74 offen nt
    buffer_load_dwordx4 v[92:95], v56, s[40:43], s75 offen nt
    buffer_load_dwordx4 v[96:99], v57, s[40:43], s68 offen nt
    buffer_load_dwordx4 v[100:103], v57, s[40:43], s69 offen nt
    buffer_load_dwordx4 v[104:107], v57, s[40:43], s70 offen nt
    buffer_load_dwordx4 v[108:111], v57, s[40:43], s71 offen nt
    s_waitcnt vmcnt(0)
    buffer_load_dwordx4 v[112:115], v57, s[40:43], s72 offen nt
    buffer_load_dwordx4 v[116:119], v57, s[40:43], s73 offen nt
    buffer_load_dwordx4 v[120:123], v57, s[40:43], s74 offen nt
    buffer_load_dwordx4 v[124:127], v57, s[40:43], s75 offen nt
    s_cmp_eq_u32 s9, 0
    s_cbranch_scc1 F_tl2
    buffer_load_dwordx4 v[128:131], v58, s[40:43], s68 offen nt
    buffer_load_dwordx4 v[132:135], v58, s[40:43], s69 offen nt
    buffer_load_dwordx4 v[136:139], v58, s[40:43], s70 offen nt
    buffer_load_dwordx4 v[140:143], v58, s[40:43], s71 offen nt
    buffer_load_dwordx4 v[144:147], v58, s[40:43], s72 offen nt
    buffer_load_dwordx4 v[148:151], v58, s[40:43], s73 offen nt
    buffer_load_dwordx4 v[152:155], v58, s[40:43], s74 offen nt
    buffer_load_dwordx4 v[156:159], v58, s[40:43], s75 offen nt
F_tl2:
    s_setprio 3
    s_setpc_b64 s[82:83]
M_stream:
    s_setprio 1
    v_lshlrev_b32 v7, 4, v1
    s_sub_u32 s73, s3, 2
    v_mov_b32 v16, -1
    v_mov_b32 v17, -1
    v_mov_b32 v18, -1
    v_mov_b32 v19, -1
    s_mul_i32 s74, s73, 6144
    v_add_u32 v25, s74, v7
    ds_write_b128 v25, v[16:19] offset:22528
    ds_write_b128 v25, v[16:19] offset:23552
    ds_write_b128 v25, v[16:19] offset:24576
    ds_write_b128 v25, v[16:19] offset:25600
    ds_write_b128 v25, v[16:19] offset:26624
    ds_write_b128 v25, v[16:19] offset:27648
    v_and_b32 v6, 3, v1
    v_lshlrev_b32 v6, 4, v6
    v_bfe_u32 v25, v1, 2, 2
    v_lshl_add_u32 v6, v25, 8, v6
    v_lshrrev_b32 v25, 4, v1
    v_lshl_add_u32 v6, v25, 6, v6
    s_lshl_b32 s71, s5, 4
    s_add_u32 s71, s71, s4
    s_lshl_b32 s71, s71, 23
    s_and_b32 s72, s6, 2
    s_lshl_b32 s72, s72, 1
    s_and_b32 s74, s6, 1
    s_lshl_b32 s74, s74, 7
    s_or_b32 s72, s72, s74
    s_and_b32 s74, s6, 4
    s_lshl_b32 s74, s74, 6
    s_or_b32 s72, s72, s74
    s_mov_b32 s76, 0xff00ff00
    s_mov_b32 s77, 0x00ff00ff
    v_mov_b32 v25, 0
    v_lshrrev_b32 v61, 2, v1
    v_lshlrev_b32 v61, 3, v61
    v_add_u32 v61, 22528, v61
    v_mov_b32 v60, v61
    s_mul_i32 s67, s73, 2
    s_sub_u32 s67, s67, 4
    s_add_u32 s75, s67, 4
    s_lshr_b32 s78, s75, 1
    s_mov_b32 s64, s72
    s_add_u32 s97, s96, s78
    s_and_b32 s97, s97, 3
    s_and_b32 s98, s78, 60
    s_or_b32 s97, s97, s98
    s_and_b32 s74, s97, 3
    s_or_b32 s64, s64, s74
    s_lshr_b32 s74, s97, 2
    s_lshl_b32 s74, s74, 3
    s_or_b32 s64, s64, s74
    s_lshl_b32 s64, s64, 1
    s_and_b32 s74, s75, 1
    s_or_b32 s64, s64, s74
    s_lshl_b32 s74, s75, 10
    s_or_b32 s64, s64, s74
    s_and_b32 s56, s64, 0x3f8
    s_lshl_b32 s56, s56, 13
    s_add_u32 s56, s56, s71
    s_and_b32 s57, s64, 3
    s_lshl_b32 s57, s57, 10
    s_or_b32 s56, s56, s57
    s_and_b32 s57, s64, 4
    s_lshl_b32 s57, s57, 12
    s_or_b32 s56, s56, s57
    s_add_u32 s57, s56, 4096
    s_add_u32 s58, s56, 8192
    s_add_u32 s59, s56, 12288
    s_add_u32 s60, s56, 32768
    s_add_u32 s61, s56, 36864
    s_add_u32 s62, s56, 40960
    s_add_u32 s63, s56, 45056
    s_waitcnt lgkmcnt(0)
    s_mov_b32 s48, s18
    s_mov_b32 s49, s19
    s_mov_b32 s50, 0x10000000
    s_mov_b32 s51, 0x20000
    s_mov_b32 s52, s20
    s_mov_b32 s53, s21
    s_mov_b32 s54, 0x10000000
    s_mov_b32 s55, 0x20000
    v_mov_b32 v22, 2048
    v_mov_b32 v23, 1
    s_cmp_ge_u32 s73, 2
    s_cbranch_scc1 L_extra
    buffer_load_dwordx4 v[192:195], v6, s[48:51], s56 offen offset:0 nt
    buffer_load_dwordx4 v[196:199], v6, s[48:51], s57 offen offset:0 nt
    buffer_load_dwordx4 v[200:203], v6, s[48:51], s58 offen offset:0 nt
    buffer_load_dwordx4 v[204:207], v6, s[48:51], s59 offen offset:0 nt
    buffer_load_dwordx4 v[208:211], v6, s[48:51], s60 offen offset:0 nt
    buffer_load_dwordx4 v[212:215], v6, s[48:51], s61 offen offset:0 nt
    buffer_load_dwordx4 v[216:219], v6, s[48:51], s62 offen offset:0 nt
    buffer_load_dwordx4 v[220:223], v6, s[48:51], s63 offen offset:0 nt
    s_add_u32 s75, s67, 5
    s_lshr_b32 s78, s75, 1
    s_mov_b32 s65, s72
    s_add_u32 s97, s96, s78
    s_and_b32 s97, s97, 3
    s_and_b32 s98, s78, 60
    s_or_b32 s97, s97, s98
    s_and_b32 s74, s97, 3
    s_or_b32 s65, s65, s74
    s_lshr_b32 s74, s97, 2
    s_lshl_b32 s74, s74, 3
    s_or_b32 s65, s65, s74
    s_lshl_b32 s65, s65, 1
    s_and_b32 s74, s75, 1
    s_or_b32 s65, s65, s74
    s_lshl_b32 s74, s75, 10
    s_or_b32 s65, s65, s74
    s_and_b32 s56, s65, 0x3f8
    s_lshl_b32 s56, s56, 13
    s_add_u32 s56, s56, s71
    s_and_b32 s57, s65, 3
    s_lshl_b32 s57, s57, 10
    s_or_b32 s56, s56, s57
    s_and_b32 s57, s65, 4
    s_lshl_b32 s57, s57, 12
    s_or_b32 s56, s56, s57
    s_add_u32 s57, s56, 4096
    s_add_u32 s58, s56, 8192
    s_add_u32 s59, s56, 12288
    s_add_u32 s60, s56, 32768
    s_add_u32 s61, s56, 36864
    s_add_u32 s62, s56, 40960
    s_add_u32 s63, s56, 45056
    buffer_load_dwordx4 v[224:227], v6, s[48:51], s56 offen offset:0 nt
    buffer_load_dwordx4 v[228:231], v6, s[48:51], s57 offen offset:0 nt
    buffer_load_dwordx4 v[232:235], v6, s[48:51], s58 offen offset:0 nt
    buffer_load_dwordx4 v[236:239], v6, s[48:51], s59 offen offset:0 nt
    buffer_load_dwordx4 v[240:243], v6, s[48:51], s60 offen offset:0 nt
    buffer_load_dwordx4 v[244:247], v6, s[48:51], s61 offen offset:0 nt
    buffer_load_dwordx4 v[248:251], v6, s[48:51], s62 offen offset:0 nt
    buffer_load_dwordx4 v[252:255], v6, s[48:51], s63 offen offset:0 nt
    s_barrier
    s_waitcnt vmcnt(16)
    s_branch L_post
L_extra:
    s_barrier
    s_sub_u32 s79, s73, 0
    s_mov_b32 s78, 0
L_tw:
    s_sleep 1
    ds_read_b32 v24, v22 offset:36
    ds_read_b32 v27, v22 offset:4
    s_waitcnt lgkmcnt(0)
    v_readfirstlane_b32 s75, v24
    v_readfirstlane_b32 s74, v27
    s_cmp_lg_u32 s74, 0
    s_cbranch_scc1 L_skip
    s_add_u32 s78, s78, 1
    s_cmp_ge_u32 s78, 2097152
    s_cbranch_scc1 L_tok
    s_cmp_lt_u32 s75, s79
    s_cbranch_scc1 L_tw
L_tok:
    v_mov_b32 v27, 6
    s_mov_b64 exec, 1
    ds_add_rtn_u32 v24, v22, v27 offset:40
    s_mov_b64 exec, -1
    s_waitcnt lgkmcnt(0)
    v_readfirstlane_b32 s67, v24
    s_bitcmp1_b32 s67, 16
    s_cbranch_scc1 L_skip
    s_add_u32 s75, s67, 0
    s_lshr_b32 s78, s75, 1
    s_mov_b32 s70, s72
    s_add_u32 s97, s96, s78
    s_and_b32 s97, s97, 3
    s_and_b32 s98, s78, 60
    s_or_b32 s97, s97, s98
    s_and_b32 s74, s97, 3
    s_or_b32 s70, s70, s74
    s_lshr_b32 s74, s97, 2
    s_lshl_b32 s74, s74, 3
    s_or_b32 s70, s70, s74
    s_lshl_b32 s70, s70, 1
    s_and_b32 s74, s75, 1
    s_or_b32 s70, s70, s74
    s_lshl_b32 s74, s75, 10
    s_or_b32 s70, s70, s74
    s_and_b32 s56, s70, 0x3f8
    s_lshl_b32 s56, s56, 13
    s_add_u32 s56, s56, s71
    s_and_b32 s57, s70, 3
    s_lshl_b32 s57, s57, 10
    s_or_b32 s56, s56, s57
    s_and_b32 s57, s70, 4
    s_lshl_b32 s57, s57, 12
    s_or_b32 s56, s56, s57
    s_add_u32 s57, s56, 4096
    s_add_u32 s58, s56, 8192
    s_add_u32 s59, s56, 12288
    s_add_u32 s60, s56, 32768
    s_add_u32 s61, s56, 36864
    s_add_u32 s62, s56, 40960
    s_add_u32 s63, s56, 45056
    buffer_load_dwordx4 v[64:67], v6, s[48:51], s56 offen offset:0 nt
    buffer_load_dwordx4 v[68:71], v6, s[48:51], s57 offen offset:0 nt
    buffer_load_dwordx4 v[72:75], v6, s[48:51], s58 offen offset:0 nt
    buffer_load_dwordx4 v[76:79], v6, s[48:51], s59 offen offset:0 nt
    buffer_load_dwordx4 v[80:83], v6, s[48:51], s60 offen offset:0 nt
    buffer_load_dwordx4 v[84:87], v6, s[48:51], s61 offen offset:0 nt
    buffer_load_dwordx4 v[88:91], v6, s[48:51], s62 offen offset:0 nt
    buffer_load_dwordx4 v[92:95], v6, s[48:51], s63 offen offset:0 nt
    s_add_u32 s75, s67, 1
    s_lshr_b32 s78, s75, 1
    s_mov_b32 s70, s72
    s_add_u32 s97, s96, s78
    s_and_b32 s97, s97, 3
    s_and_b32 s98, s78, 60
    s_or_b32 s97, s97, s98
    s_and_b32 s74, s97, 3
    s_or_b32 s70, s70, s74
    s_lshr_b32 s74, s97, 2
    s_lshl_b32 s74, s74, 3
    s_or_b32 s70, s70, s74
    s_lshl_b32 s70, s70, 1
    s_and_b32 s74, s75, 1
    s_or_b32 s70, s70, s74
    s_lshl_b32 s74, s75, 10
    s_or_b32 s70, s70, s74
    s_and_b32 s56, s70, 0x3f8
    s_lshl_b32 s56, s56, 13
    s_add_u32 s56, s56, s71
    s_and_b32 s57, s70, 3
    s_lshl_b32 s57, s57, 10
    s_or_b32 s56, s56, s57
    s_and_b32 s57, s70, 4
    s_lshl_b32 s57, s57, 12
    s_or_b32 s56, s56, s57
    s_add_u32 s57, s56, 4096
    s_add_u32 s58, s56, 8192
    s_add_u32 s59, s56, 12288
    s_add_u32 s60, s56, 32768
    s_add_u32 s61, s56, 36864
    s_add_u32 s62, s56, 40960
    s_add_u32 s63, s56, 45056
    buffer_load_dwordx4 v[96:99], v6, s[48:51], s56 offen offset:0 nt
    buffer_load_dwordx4 v[100:103], v6, s[48:51], s57 offen offset:0 nt
    buffer_load_dwordx4 v[104:107], v6, s[48:51], s58 offen offset:0 nt
    buffer_load_dwordx4 v[108:111], v6, s[48:51], s59 offen offset:0 nt
    buffer_load_dwordx4 v[112:115], v6, s[48:51], s60 offen offset:0 nt
    buffer_load_dwordx4 v[116:119], v6, s[48:51], s61 offen offset:0 nt
    buffer_load_dwordx4 v[120:123], v6, s[48:51], s62 offen offset:0 nt
    buffer_load_dwordx4 v[124:127], v6, s[48:51], s63 offen offset:0 nt
    s_add_u32 s75, s67, 2
    s_lshr_b32 s78, s75, 1
    s_mov_b32 s70, s72
    s_add_u32 s97, s96, s78
    s_and_b32 s97, s97, 3
    s_and_b32 s98, s78, 60
    s_or_b32 s97, s97, s98
    s_and_b32 s74, s97, 3
    s_or_b32 s70, s70, s74
    s_lshr_b32 s74, s97, 2
    s_lshl_b32 s74, s74, 3
    s_or_b32 s70, s70, s74
    s_lshl_b32 s70, s70, 1
    s_and_b32 s74, s75, 1
    s_or_b32 s70, s70, s74
    s_lshl_b32 s74, s75, 10
    s_or_b32 s70, s70, s74
    s_and_b32 s56, s70, 0x3f8
    s_lshl_b32 s56, s56, 13
    s_add_u32 s56, s56, s71
    s_and_b32 s57, s70, 3
    s_lshl_b32 s57, s57, 10
    s_or_b32 s56, s56, s57
    s_and_b32 s57, s70, 4
    s_lshl_b32 s57, s57, 12
    s_or_b32 s56, s56, s57
    s_add_u32 s57, s56, 4096
    s_add_u32 s58, s56, 8192
    s_add_u32 s59, s56, 12288
    s_add_u32 s60, s56, 32768
    s_add_u32 s61, s56, 36864
    s_add_u32 s62, s56, 40960
    s_add_u32 s63, s56, 45056
    buffer_load_dwordx4 v[128:131], v6, s[48:51], s56 offen offset:0 nt
    buffer_load_dwordx4 v[132:135], v6, s[48:51], s57 offen offset:0 nt
    buffer_load_dwordx4 v[136:139], v6, s[48:51], s58 offen offset:0 nt
    buffer_load_dwordx4 v[140:143], v6, s[48:51], s59 offen offset:0 nt
    buffer_load_dwordx4 v[144:147], v6, s[48:51], s60 offen offset:0 nt
    buffer_load_dwordx4 v[148:151], v6, s[48:51], s61 offen offset:0 nt
    buffer_load_dwordx4 v[152:155], v6, s[48:51], s62 offen offset:0 nt
    buffer_load_dwordx4 v[156:159], v6, s[48:51], s63 offen offset:0 nt
    s_add_u32 s75, s67, 3
    s_lshr_b32 s78, s75, 1
    s_mov_b32 s70, s72
    s_add_u32 s97, s96, s78
    s_and_b32 s97, s97, 3
    s_and_b32 s98, s78, 60
    s_or_b32 s97, s97, s98
    s_and_b32 s74, s97, 3
    s_or_b32 s70, s70, s74
    s_lshr_b32 s74, s97, 2
    s_lshl_b32 s74, s74, 3
    s_or_b32 s70, s70, s74
    s_lshl_b32 s70, s70, 1
    s_and_b32 s74, s75, 1
    s_or_b32 s70, s70, s74
    s_lshl_b32 s74, s75, 10
    s_or_b32 s70, s70, s74
    s_and_b32 s56, s70, 0x3f8
    s_lshl_b32 s56, s56, 13
    s_add_u32 s56, s56, s71
    s_and_b32 s57, s70, 3
    s_lshl_b32 s57, s57, 10
    s_or_b32 s56, s56, s57
    s_and_b32 s57, s70, 4
    s_lshl_b32 s57, s57, 12
    s_or_b32 s56, s56, s57
    s_add_u32 s57, s56, 4096
    s_add_u32 s58, s56, 8192
    s_add_u32 s59, s56, 12288
    s_add_u32 s60, s56, 32768
    s_add_u32 s61, s56, 36864
    s_add_u32 s62, s56, 40960
    s_add_u32 s63, s56, 45056
    s_waitcnt vmcnt(16)
    buffer_load_dwordx4 v[160:163], v6, s[48:51], s56 offen offset:0 nt
    buffer_load_dwordx4 v[164:167], v6, s[48:51], s57 offen offset:0 nt
    buffer_load_dwordx4 v[168:171], v6, s[48:51], s58 offen offset:0 nt
    buffer_load_dwordx4 v[172:175], v6, s[48:51], s59 offen offset:0 nt
    buffer_load_dwordx4 v[176:179], v6, s[48:51], s60 offen offset:0 nt
    buffer_load_dwordx4 v[180:183], v6, s[48:51], s61 offen offset:0 nt
    buffer_load_dwordx4 v[184:187], v6, s[48:51], s62 offen offset:0 nt
    buffer_load_dwordx4 v[188:191], v6, s[48:51], s63 offen offset:0 nt
    s_add_u32 s75, s67, 4
    s_lshr_b32 s78, s75, 1
    s_mov_b32 s64, s72
    s_add_u32 s97, s96, s78
    s_and_b32 s97, s97, 3
    s_and_b32 s98, s78, 60
    s_or_b32 s97, s97, s98
    s_and_b32 s74, s97, 3
    s_or_b32 s64, s64, s74
    s_lshr_b32 s74, s97, 2
    s_lshl_b32 s74, s74, 3
    s_or_b32 s64, s64, s74
    s_lshl_b32 s64, s64, 1
    s_and_b32 s74, s75, 1
    s_or_b32 s64, s64, s74
    s_lshl_b32 s74, s75, 10
    s_or_b32 s64, s64, s74
    s_and_b32 s56, s64, 0x3f8
    s_lshl_b32 s56, s56, 13
    s_add_u32 s56, s56, s71
    s_and_b32 s57, s64, 3
    s_lshl_b32 s57, s57, 10
    s_or_b32 s56, s56, s57
    s_and_b32 s57, s64, 4
    s_lshl_b32 s57, s57, 12
    s_or_b32 s56, s56, s57
    s_add_u32 s57, s56, 4096
    s_add_u32 s58, s56, 8192
    s_add_u32 s59, s56, 12288
    s_add_u32 s60, s56, 32768
    s_add_u32 s61, s56, 36864
    s_add_u32 s62, s56, 40960
    s_add_u32 s63, s56, 45056
    s_waitcnt vmcnt(16)
    buffer_load_dwordx4 v[192:195], v6, s[48:51], s56 offen offset:0 nt
    buffer_load_dwordx4 v[196:199], v6, s[48:51], s57 offen offset:0 nt
    buffer_load_dwordx4 v[200:203], v6, s[48:51], s58 offen offset:0 nt
    buffer_load_dwordx4 v[204:207], v6, s[48:51], s59 offen offset:0 nt
    buffer_load_dwordx4 v[208:211], v6, s[48:51], s60 offen offset:0 nt
    buffer_load_dwordx4 v[212:215], v6, s[48:51], s61 offen offset:0 nt
    buffer_load_dwordx4 v[216:219], v6, s[48:51], s62 offen offset:0 nt
    buffer_load_dwordx4 v[220:223], v6, s[48:51], s63 offen offset:0 nt
    s_add_u32 s75, s67, 5
    s_lshr_b32 s78, s75, 1
    s_mov_b32 s65, s72
    s_add_u32 s97, s96, s78
    s_and_b32 s97, s97, 3
    s_and_b32 s98, s78, 60
    s_or_b32 s97, s97, s98
    s_and_b32 s74, s97, 3
    s_or_b32 s65, s65, s74
    s_lshr_b32 s74, s97, 2
    s_lshl_b32 s74, s74, 3
    s_or_b32 s65, s65, s74
    s_lshl_b32 s65, s65, 1
    s_and_b32 s74, s75, 1
    s_or_b32 s65, s65, s74
    s_lshl_b32 s74, s75, 10
    s_or_b32 s65, s65, s74
    s_and_b32 s56, s65, 0x3f8
    s_lshl_b32 s56, s56, 13
    s_add_u32 s56, s56, s71
    s_and_b32 s57, s65, 3
    s_lshl_b32 s57, s57, 10
    s_or_b32 s56, s56, s57
    s_and_b32 s57, s65, 4
    s_lshl_b32 s57, s57, 12
    s_or_b32 s56, s56, s57
    s_add_u32 s57, s56, 4096
    s_add_u32 s58, s56, 8192
    s_add_u32 s59, s56, 12288
    s_add_u32 s60, s56, 32768
    s_add_u32 s61, s56, 36864
    s_add_u32 s62, s56, 40960
    s_add_u32 s63, s56, 45056
    s_waitcnt vmcnt(16)
    buffer_load_dwordx4 v[224:227], v6, s[48:51], s56 offen offset:0 nt
    buffer_load_dwordx4 v[228:231], v6, s[48:51], s57 offen offset:0 nt
    buffer_load_dwordx4 v[232:235], v6, s[48:51], s58 offen offset:0 nt
    buffer_load_dwordx4 v[236:239], v6, s[48:51], s59 offen offset:0 nt
    buffer_load_dwordx4 v[240:243], v6, s[48:51], s60 offen offset:0 nt
    buffer_load_dwordx4 v[244:247], v6, s[48:51], s61 offen offset:0 nt
    buffer_load_dwordx4 v[248:251], v6, s[48:51], s62 offen offset:0 nt
    buffer_load_dwordx4 v[252:255], v6, s[48:51], s63 offen offset:0 nt
    s_waitcnt vmcnt(16)
L_post:
    s_mov_b64 exec, 1
    ds_add_u32 v22, v23 offset:36
    s_mov_b64 exec, -1
    v_and_b32 v8, 1, v1
    v_lshlrev_b32 v8, 4, v8
    v_mov_b32 v9, 0xffff
    v_lshlrev_b32 v8, v8, v9
    v_bfe_u32 v9, v1, 1, 2
    v_cmp_eq_u32 vcc, 0, v9
    s_nop 1
    v_cndmask_b32 v2, 0, v8, vcc
    v_cmp_eq_u32 vcc, 1, v9
    s_nop 1
    v_cndmask_b32 v3, 0, v8, vcc
    v_cmp_eq_u32 vcc, 2, v9
    s_nop 1
    v_cndmask_b32 v4, 0, v8, vcc
    v_cmp_eq_u32 vcc, 3, v9
    s_nop 1
    v_cndmask_b32 v5, 0, v8, vcc
    v_mov_b32 v16, 0
    v_mov_b32 v17, 0
    v_mov_b32 v18, 0
    v_mov_b32 v19, 0
    v_mov_b32 v20, 0xff167699
    v_mov_b32 v26, 0x7f591297
    v_mov_b32 v21, 0
    v_mov_b32 v22, 2048
    v_mov_b32 v23, 1
    v_bfe_u32 v25, v1, 3, 1
    v_lshlrev_b32 v25, 8, v25
    v_lshrrev_b32 v27, 4, v1
    v_lshl_add_u32 v25, v27, 6, v25
    v_and_b32 v27, 3, v1
    v_lshl_add_u32 v25, v27, 4, v25
    v_and_b32 v27, 4, v1
    v_cmp_eq_u32 vcc, 0, v27
    s_lshl_b32 s74, s67, 7
    v_add_u32 v60, s74, v61
    s_mov_b32 s44, s38
    s_mov_b32 s45, s39
    s_mov_b32 s46, 0x800000
    s_mov_b32 s47, 0x20000
    s_and_b32 s74, s2, 15
    s_lshl_b32 s68, s2, 11
    s_add_u32 s68, s68, 1048576
    s_lshl_b32 s69, s4, 8
    s_lshl_b32 s75, s74, 3
    s_add_u32 s69, s69, s75
    s_add_u32 s69, s69, 262144
    s_mov_b32 s78, 0
L_qw:
    ds_read_b32 v24, v22 offset:4
    s_waitcnt lgkmcnt(0)
    v_readfirstlane_b32 s75, v24
    s_cmp_lg_u32 s75, 0
    s_cbranch_scc1 L_qok
    s_sleep 2
    s_add_u32 s78, s78, 1
    s_cmp_lt_u32 s78, 2097152
    s_cbranch_scc1 L_qw
L_qok:
    ds_read_b128 v[28:31], v25 offset:6912
    s_waitcnt lgkmcnt(0)
    v_cndmask_b32 v8, 0, v28, vcc
    v_cndmask_b32 v12, v28, 0, vcc
    v_cndmask_b32 v9, 0, v29, vcc
    v_cndmask_b32 v13, v29, 0, vcc
    v_cndmask_b32 v10, 0, v30, vcc
    v_cndmask_b32 v14, v30, 0, vcc
    v_cndmask_b32 v11, 0, v31, vcc
    v_cndmask_b32 v15, v31, 0, vcc
    s_mov_b32 s79, 0
    s_cmp_lt_u32 s73, 2
    s_cbranch_scc1 L_keep
    s_waitcnt vmcnt(40)
    v_mfma_f32_16x16x32_bf16 v[28:31], v[64:67], v[8:11], 0
    v_mfma_f32_16x16x32_bf16 v[32:35], v[72:75], v[8:11], 0
    v_mfma_f32_16x16x32_bf16 v[36:39], v[80:83], v[8:11], 0
    v_mfma_f32_16x16x32_bf16 v[40:43], v[88:91], v[8:11], 0
    v_mfma_f32_16x16x32_bf16 v[28:31], v[68:71], v[12:15], v[28:31]
    v_mfma_f32_16x16x32_bf16 v[32:35], v[76:79], v[12:15], v[32:35]
    v_mfma_f32_16x16x32_bf16 v[36:39], v[84:87], v[12:15], v[36:39]
    v_mfma_f32_16x16x32_bf16 v[40:43], v[92:95], v[12:15], v[40:43]
    s_nop 4
    v_mov_b32_dpp v44, v28 quad_perm:[0,0,0,0] row_mask:0xf bank_mask:0xf
    v_mov_b32_dpp v48, v30 quad_perm:[2,2,2,2] row_mask:0xf bank_mask:0xf
    v_mov_b32_dpp v45, v32 quad_perm:[0,0,0,0] row_mask:0xf bank_mask:0xf
    v_mov_b32_dpp v49, v34 quad_perm:[2,2,2,2] row_mask:0xf bank_mask:0xf
    v_mov_b32_dpp v46, v36 quad_perm:[0,0,0,0] row_mask:0xf bank_mask:0xf
    v_mov_b32_dpp v50, v38 quad_perm:[2,2,2,2] row_mask:0xf bank_mask:0xf
    v_mov_b32_dpp v47, v40 quad_perm:[0,0,0,0] row_mask:0xf bank_mask:0xf
    v_mov_b32_dpp v51, v42 quad_perm:[2,2,2,2] row_mask:0xf bank_mask:0xf
    v_add_f32_dpp v44, v29, v44 quad_perm:[1,1,1,1] row_mask:0xf bank_mask:0xf
    v_add_f32_dpp v48, v31, v48 quad_perm:[3,3,3,3] row_mask:0xf bank_mask:0xf
    v_add_f32_dpp v45, v33, v45 quad_perm:[1,1,1,1] row_mask:0xf bank_mask:0xf
    v_add_f32_dpp v49, v35, v49 quad_perm:[3,3,3,3] row_mask:0xf bank_mask:0xf
    v_add_f32_dpp v46, v37, v46 quad_perm:[1,1,1,1] row_mask:0xf bank_mask:0xf
    v_add_f32_dpp v50, v39, v50 quad_perm:[3,3,3,3] row_mask:0xf bank_mask:0xf
    v_add_f32_dpp v47, v41, v47 quad_perm:[1,1,1,1] row_mask:0xf bank_mask:0xf
    v_add_f32_dpp v51, v43, v51 quad_perm:[3,3,3,3] row_mask:0xf bank_mask:0xf
    v_add_f32 v44, v44, v48
    v_add_f32 v45, v45, v49
    v_add_f32 v46, v46, v50
    v_add_f32 v47, v47, v51
    v_cvt_pk_bf16_f32 v48, v44, v45
    v_lshlrev_b32 v44, 16, v48
    v_and_b32 v45, 0xffff0000, v48
    v_cvt_pk_bf16_f32 v49, v46, v47
    v_lshlrev_b32 v46, 16, v49
    v_and_b32 v47, 0xffff0000, v49
    v_mul_f32 v44, s10, v44
    v_mul_f32 v45, s10, v45
    v_mul_f32 v46, s10, v46
    v_mul_f32 v47, s10, v47
    v_cvt_pk_bf16_f32 v48, v44, v45
    v_cvt_pk_bf16_f32 v49, v46, v47
    v_min_u32 v48, -2, v48
    v_min_u32 v49, -2, v49
    ds_write_b64 v60, v[48:49]
    v_add_u32 v60, 128, v60
    s_waitcnt vmcnt(32)
    v_mfma_f32_16x16x32_bf16 v[28:31], v[96:99], v[8:11], 0
    v_mfma_f32_16x16x32_bf16 v[32:35], v[104:107], v[8:11], 0
    v_mfma_f32_16x16x32_bf16 v[36:39], v[112:115], v[8:11], 0
    v_mfma_f32_16x16x32_bf16 v[40:43], v[120:123], v[8:11], 0
    v_mfma_f32_16x16x32_bf16 v[28:31], v[100:103], v[12:15], v[28:31]
    v_mfma_f32_16x16x32_bf16 v[32:35], v[108:111], v[12:15], v[32:35]
    v_mfma_f32_16x16x32_bf16 v[36:39], v[116:119], v[12:15], v[36:39]
    v_mfma_f32_16x16x32_bf16 v[40:43], v[124:127], v[12:15], v[40:43]
    s_nop 4
    v_mov_b32_dpp v44, v28 quad_perm:[0,0,0,0] row_mask:0xf bank_mask:0xf
    v_mov_b32_dpp v48, v30 quad_perm:[2,2,2,2] row_mask:0xf bank_mask:0xf
    v_mov_b32_dpp v45, v32 quad_perm:[0,0,0,0] row_mask:0xf bank_mask:0xf
    v_mov_b32_dpp v49, v34 quad_perm:[2,2,2,2] row_mask:0xf bank_mask:0xf
    v_mov_b32_dpp v46, v36 quad_perm:[0,0,0,0] row_mask:0xf bank_mask:0xf
    v_mov_b32_dpp v50, v38 quad_perm:[2,2,2,2] row_mask:0xf bank_mask:0xf
    v_mov_b32_dpp v47, v40 quad_perm:[0,0,0,0] row_mask:0xf bank_mask:0xf
    v_mov_b32_dpp v51, v42 quad_perm:[2,2,2,2] row_mask:0xf bank_mask:0xf
    v_add_f32_dpp v44, v29, v44 quad_perm:[1,1,1,1] row_mask:0xf bank_mask:0xf
    v_add_f32_dpp v48, v31, v48 quad_perm:[3,3,3,3] row_mask:0xf bank_mask:0xf
    v_add_f32_dpp v45, v33, v45 quad_perm:[1,1,1,1] row_mask:0xf bank_mask:0xf
    v_add_f32_dpp v49, v35, v49 quad_perm:[3,3,3,3] row_mask:0xf bank_mask:0xf
    v_add_f32_dpp v46, v37, v46 quad_perm:[1,1,1,1] row_mask:0xf bank_mask:0xf
    v_add_f32_dpp v50, v39, v50 quad_perm:[3,3,3,3] row_mask:0xf bank_mask:0xf
    v_add_f32_dpp v47, v41, v47 quad_perm:[1,1,1,1] row_mask:0xf bank_mask:0xf
    v_add_f32_dpp v51, v43, v51 quad_perm:[3,3,3,3] row_mask:0xf bank_mask:0xf
    v_add_f32 v44, v44, v48
    v_add_f32 v45, v45, v49
    v_add_f32 v46, v46, v50
    v_add_f32 v47, v47, v51
    v_cvt_pk_bf16_f32 v48, v44, v45
    v_lshlrev_b32 v44, 16, v48
    v_and_b32 v45, 0xffff0000, v48
    v_cvt_pk_bf16_f32 v49, v46, v47
    v_lshlrev_b32 v46, 16, v49
    v_and_b32 v47, 0xffff0000, v49
    v_mul_f32 v44, s10, v44
    v_mul_f32 v45, s10, v45
    v_mul_f32 v46, s10, v46
    v_mul_f32 v47, s10, v47
    v_cvt_pk_bf16_f32 v48, v44, v45
    v_cvt_pk_bf16_f32 v49, v46, v47
    v_min_u32 v48, -2, v48
    v_min_u32 v49, -2, v49
    ds_write_b64 v60, v[48:49]
    v_add_u32 v60, 128, v60
    s_waitcnt vmcnt(24)
    v_mfma_f32_16x16x32_bf16 v[28:31], v[128:131], v[8:11], 0
    v_mfma_f32_16x16x32_bf16 v[32:35], v[136:139], v[8:11], 0
    v_mfma_f32_16x16x32_bf16 v[36:39], v[144:147], v[8:11], 0
    v_mfma_f32_16x16x32_bf16 v[40:43], v[152:155], v[8:11], 0
    v_mfma_f32_16x16x32_bf16 v[28:31], v[132:135], v[12:15], v[28:31]
    v_mfma_f32_16x16x32_bf16 v[32:35], v[140:143], v[12:15], v[32:35]
    v_mfma_f32_16x16x32_bf16 v[36:39], v[148:151], v[12:15], v[36:39]
    v_mfma_f32_16x16x32_bf16 v[40:43], v[156:159], v[12:15], v[40:43]
    s_nop 4
    v_mov_b32_dpp v44, v28 quad_perm:[0,0,0,0] row_mask:0xf bank_mask:0xf
    v_mov_b32_dpp v48, v30 quad_perm:[2,2,2,2] row_mask:0xf bank_mask:0xf
    v_mov_b32_dpp v45, v32 quad_perm:[0,0,0,0] row_mask:0xf bank_mask:0xf
    v_mov_b32_dpp v49, v34 quad_perm:[2,2,2,2] row_mask:0xf bank_mask:0xf
    v_mov_b32_dpp v46, v36 quad_perm:[0,0,0,0] row_mask:0xf bank_mask:0xf
    v_mov_b32_dpp v50, v38 quad_perm:[2,2,2,2] row_mask:0xf bank_mask:0xf
    v_mov_b32_dpp v47, v40 quad_perm:[0,0,0,0] row_mask:0xf bank_mask:0xf
    v_mov_b32_dpp v51, v42 quad_perm:[2,2,2,2] row_mask:0xf bank_mask:0xf
    v_add_f32_dpp v44, v29, v44 quad_perm:[1,1,1,1] row_mask:0xf bank_mask:0xf
    v_add_f32_dpp v48, v31, v48 quad_perm:[3,3,3,3] row_mask:0xf bank_mask:0xf
    v_add_f32_dpp v45, v33, v45 quad_perm:[1,1,1,1] row_mask:0xf bank_mask:0xf
    v_add_f32_dpp v49, v35, v49 quad_perm:[3,3,3,3] row_mask:0xf bank_mask:0xf
    v_add_f32_dpp v46, v37, v46 quad_perm:[1,1,1,1] row_mask:0xf bank_mask:0xf
    v_add_f32_dpp v50, v39, v50 quad_perm:[3,3,3,3] row_mask:0xf bank_mask:0xf
    v_add_f32_dpp v47, v41, v47 quad_perm:[1,1,1,1] row_mask:0xf bank_mask:0xf
    v_add_f32_dpp v51, v43, v51 quad_perm:[3,3,3,3] row_mask:0xf bank_mask:0xf
    v_add_f32 v44, v44, v48
    v_add_f32 v45, v45, v49
    v_add_f32 v46, v46, v50
    v_add_f32 v47, v47, v51
    v_cvt_pk_bf16_f32 v48, v44, v45
    v_lshlrev_b32 v44, 16, v48
    v_and_b32 v45, 0xffff0000, v48
    v_cvt_pk_bf16_f32 v49, v46, v47
    v_lshlrev_b32 v46, 16, v49
    v_and_b32 v47, 0xffff0000, v49
    v_mul_f32 v44, s10, v44
    v_mul_f32 v45, s10, v45
    v_mul_f32 v46, s10, v46
    v_mul_f32 v47, s10, v47
    v_cvt_pk_bf16_f32 v48, v44, v45
    v_cvt_pk_bf16_f32 v49, v46, v47
    v_min_u32 v48, -2, v48
    v_min_u32 v49, -2, v49
    ds_write_b64 v60, v[48:49]
    v_add_u32 v60, 128, v60
    s_waitcnt vmcnt(16)
    v_mfma_f32_16x16x32_bf16 v[28:31], v[160:163], v[8:11], 0
    v_mfma_f32_16x16x32_bf16 v[32:35], v[168:171], v[8:11], 0
    v_mfma_f32_16x16x32_bf16 v[36:39], v[176:179], v[8:11], 0
    v_mfma_f32_16x16x32_bf16 v[40:43], v[184:187], v[8:11], 0
    v_mfma_f32_16x16x32_bf16 v[28:31], v[164:167], v[12:15], v[28:31]
    v_mfma_f32_16x16x32_bf16 v[32:35], v[172:175], v[12:15], v[32:35]
    v_mfma_f32_16x16x32_bf16 v[36:39], v[180:183], v[12:15], v[36:39]
    v_mfma_f32_16x16x32_bf16 v[40:43], v[188:191], v[12:15], v[40:43]
    s_nop 4
    v_mov_b32_dpp v44, v28 quad_perm:[0,0,0,0] row_mask:0xf bank_mask:0xf
    v_mov_b32_dpp v48, v30 quad_perm:[2,2,2,2] row_mask:0xf bank_mask:0xf
    v_mov_b32_dpp v45, v32 quad_perm:[0,0,0,0] row_mask:0xf bank_mask:0xf
    v_mov_b32_dpp v49, v34 quad_perm:[2,2,2,2] row_mask:0xf bank_mask:0xf
    v_mov_b32_dpp v46, v36 quad_perm:[0,0,0,0] row_mask:0xf bank_mask:0xf
    v_mov_b32_dpp v50, v38 quad_perm:[2,2,2,2] row_mask:0xf bank_mask:0xf
    v_mov_b32_dpp v47, v40 quad_perm:[0,0,0,0] row_mask:0xf bank_mask:0xf
    v_mov_b32_dpp v51, v42 quad_perm:[2,2,2,2] row_mask:0xf bank_mask:0xf
    v_add_f32_dpp v44, v29, v44 quad_perm:[1,1,1,1] row_mask:0xf bank_mask:0xf
    v_add_f32_dpp v48, v31, v48 quad_perm:[3,3,3,3] row_mask:0xf bank_mask:0xf
    v_add_f32_dpp v45, v33, v45 quad_perm:[1,1,1,1] row_mask:0xf bank_mask:0xf
    v_add_f32_dpp v49, v35, v49 quad_perm:[3,3,3,3] row_mask:0xf bank_mask:0xf
    v_add_f32_dpp v46, v37, v46 quad_perm:[1,1,1,1] row_mask:0xf bank_mask:0xf
    v_add_f32_dpp v50, v39, v50 quad_perm:[3,3,3,3] row_mask:0xf bank_mask:0xf
    v_add_f32_dpp v47, v41, v47 quad_perm:[1,1,1,1] row_mask:0xf bank_mask:0xf
    v_add_f32_dpp v51, v43, v51 quad_perm:[3,3,3,3] row_mask:0xf bank_mask:0xf
    v_add_f32 v44, v44, v48
    v_add_f32 v45, v45, v49
    v_add_f32 v46, v46, v50
    v_add_f32 v47, v47, v51
    v_cvt_pk_bf16_f32 v48, v44, v45
    v_lshlrev_b32 v44, 16, v48
    v_and_b32 v45, 0xffff0000, v48
    v_cvt_pk_bf16_f32 v49, v46, v47
    v_lshlrev_b32 v46, 16, v49
    v_and_b32 v47, 0xffff0000, v49
    v_mul_f32 v44, s10, v44
    v_mul_f32 v45, s10, v45
    v_mul_f32 v46, s10, v46
    v_mul_f32 v47, s10, v47
    v_cvt_pk_bf16_f32 v48, v44, v45
    v_cvt_pk_bf16_f32 v49, v46, v47
    v_min_u32 v48, -2, v48
    v_min_u32 v49, -2, v49
    ds_write_b64 v60, v[48:49]
    v_add_u32 v60, 128, v60
    s_mov_b32 s79, 2
    v_mov_b32 v23, 0
L_keep:
    s_nop 1
L_loop:
    s_bfe_u32 s74, s64, 0xa000a
    s_lshl_b32 s74, s74, 7
    v_add_u32 v60, s74, v61
    s_bitcmp1_b32 s64, 20
    s_cbranch_scc1 L_isv4
    s_waitcnt vmcnt(8)
    s_cmp_eq_u32 s79, 0
    s_cbranch_scc1 L_vw_11
    s_waitcnt vmcnt(0)
L_vw_11:
    s_mov_b64 exec, 1
    ds_add_rtn_u32 v24, v22, v23
    s_mov_b64 exec, -1
    v_mfma_f32_16x16x32_bf16 v[28:31], v[192:195], v[8:11], 0
    v_mfma_f32_16x16x32_bf16 v[32:35], v[200:203], v[8:11], 0
    v_mfma_f32_16x16x32_bf16 v[36:39], v[208:211], v[8:11], 0
    v_mfma_f32_16x16x32_bf16 v[40:43], v[216:219], v[8:11], 0
    v_mfma_f32_16x16x32_bf16 v[28:31], v[196:199], v[12:15], v[28:31]
    v_mfma_f32_16x16x32_bf16 v[32:35], v[204:207], v[12:15], v[32:35]
    v_mfma_f32_16x16x32_bf16 v[36:39], v[212:215], v[12:15], v[36:39]
    v_mfma_f32_16x16x32_bf16 v[40:43], v[220:223], v[12:15], v[40:43]
    s_waitcnt lgkmcnt(0)
    v_readfirstlane_b32 s75, v24
    s_min_u32 s75, s75, 1023
    s_lshl_b32 s75, s75, 2
    v_mov_b32 v25, s75
    ds_read_b32 v27, v25 offset:18432
    v_mov_b32_dpp v44, v28 quad_perm:[0,0,0,0] row_mask:0xf bank_mask:0xf
    v_mov_b32_dpp v48, v30 quad_perm:[2,2,2,2] row_mask:0xf bank_mask:0xf
    v_mov_b32_dpp v45, v32 quad_perm:[0,0,0,0] row_mask:0xf bank_mask:0xf
    v_mov_b32_dpp v49, v34 quad_perm:[2,2,2,2] row_mask:0xf bank_mask:0xf
    v_mov_b32_dpp v46, v36 quad_perm:[0,0,0,0] row_mask:0xf bank_mask:0xf
    v_mov_b32_dpp v50, v38 quad_perm:[2,2,2,2] row_mask:0xf bank_mask:0xf
    v_mov_b32_dpp v47, v40 quad_perm:[0,0,0,0] row_mask:0xf bank_mask:0xf
    v_mov_b32_dpp v51, v42 quad_perm:[2,2,2,2] row_mask:0xf bank_mask:0xf
    v_add_f32_dpp v44, v29, v44 quad_perm:[1,1,1,1] row_mask:0xf bank_mask:0xf
    v_add_f32_dpp v48, v31, v48 quad_perm:[3,3,3,3] row_mask:0xf bank_mask:0xf
    v_add_f32_dpp v45, v33, v45 quad_perm:[1,1,1,1] row_mask:0xf bank_mask:0xf
    v_add_f32_dpp v49, v35, v49 quad_perm:[3,3,3,3] row_mask:0xf bank_mask:0xf
    v_add_f32_dpp v46, v37, v46 quad_perm:[1,1,1,1] row_mask:0xf bank_mask:0xf
    v_add_f32_dpp v50, v39, v50 quad_perm:[3,3,3,3] row_mask:0xf bank_mask:0xf
    v_add_f32_dpp v47, v41, v47 quad_perm:[1,1,1,1] row_mask:0xf bank_mask:0xf
    v_add_f32_dpp v51, v43, v51 quad_perm:[3,3,3,3] row_mask:0xf bank_mask:0xf
    v_add_f32 v44, v44, v48
    v_add_f32 v45, v45, v49
    v_add_f32 v46, v46, v50
    v_add_f32 v47, v47, v51
    v_cvt_pk_bf16_f32 v48, v44, v45
    v_lshlrev_b32 v44, 16, v48
    v_and_b32 v45, 0xffff0000, v48
    v_cvt_pk_bf16_f32 v49, v46, v47
    v_lshlrev_b32 v46, 16, v49
    v_and_b32 v47, 0xffff0000, v49
    v_mul_f32 v44, s10, v44
    v_mul_f32 v45, s10, v45
    v_mul_f32 v46, s10, v46
    v_mul_f32 v47, s10, v47
    v_cvt_pk_bf16_f32 v48, v44, v45
    v_cvt_pk_bf16_f32 v49, v46, v47
    v_min_u32 v48, -2, v48
    v_min_u32 v49, -2, v49
    ds_write_b64 v60, v[48:49]
    s_branch L_cd4
L_isv4:
    ds_read_b64 v[62:63], v60
    s_mov_b32 s78, 0
L_sw4:
    s_waitcnt lgkmcnt(0)
    v_max_u32 v39, v62, v63
    v_cmp_eq_u32 vcc, -1, v39
    s_cbranch_vccz L_sok4
    ds_read_b64 v[62:63], v60
    s_add_u32 s78, s78, 1
    s_cmp_lt_u32 s78, 4194304
    s_cbranch_scc1 L_sw4
L_sok4:
    v_lshlrev_b32 v28, 16, v62
    v_and_b32 v29, 0xffff0000, v62
    v_lshlrev_b32 v30, 16, v63
    v_and_b32 v31, 0xffff0000, v63
    v_max3_f32 v39, v28, v29, v30
    v_max_f32 v39, v39, v31
    v_cmp_gt_f32 vcc, v39, v20
    s_cbranch_vccz L_back4
    s_call_b64 s[80:81], L_slow
L_back4:
    v_fma_f32 v28, v28, s11, v26
    v_fma_f32 v29, v29, s11, v26
    v_fma_f32 v30, v30, s11, v26
    v_fma_f32 v31, v31, s11, v26
    v_exp_f32 v28, v28
    v_exp_f32 v29, v29
    v_exp_f32 v30, v30
    v_exp_f32 v31, v31
    v_cvt_pk_bf16_f32 v32, v28, v28
    v_cvt_pk_bf16_f32 v33, v29, v29
    v_cvt_pk_bf16_f32 v34, v30, v30
    v_cvt_pk_bf16_f32 v35, v31, v31
    v_add_f32 v36, v28, v29
    v_add_f32 v37, v30, v31
    v_and_b32 v44, v32, v2
    v_and_b32 v45, v32, v3
    v_and_b32_dpp v46, v32, v4 row_half_mirror row_mask:0xf bank_mask:0xf
    v_and_b32_dpp v47, v32, v5 row_half_mirror row_mask:0xf bank_mask:0xf
    v_and_b32_dpp v48, v32, v2 row_half_mirror row_mask:0xf bank_mask:0xf
    v_and_b32_dpp v49, v32, v3 row_half_mirror row_mask:0xf bank_mask:0xf
    v_and_b32 v50, v32, v4
    v_and_b32 v51, v32, v5
    v_and_b32 v52, v33, v2
    v_and_b32 v53, v33, v3
    v_and_b32_dpp v54, v33, v4 row_half_mirror row_mask:0xf bank_mask:0xf
    v_and_b32_dpp v55, v33, v5 row_half_mirror row_mask:0xf bank_mask:0xf
    v_and_b32_dpp v56, v33, v2 row_half_mirror row_mask:0xf bank_mask:0xf
    v_and_b32_dpp v57, v33, v3 row_half_mirror row_mask:0xf bank_mask:0xf
    v_and_b32 v58, v33, v4
    v_and_b32 v59, v33, v5
    v_add_f32 v21, v21, v36
    v_add_f32 v21, v21, v37
    s_cbranch_execz L_g_12
    s_waitcnt vmcnt(8)
    s_cmp_eq_u32 s79, 0
    s_cbranch_scc1 L_vw_13
    s_waitcnt vmcnt(0)
L_vw_13:
    s_mov_b64 exec, 1
    ds_add_rtn_u32 v24, v22, v23
    s_mov_b64 exec, -1
L_g_12:
    v_mfma_f32_16x16x32_bf16 v[16:19], v[44:47], v[192:195], v[16:19]
    v_mfma_f32_16x16x32_bf16 v[16:19], v[48:51], v[196:199], v[16:19]
    v_and_b32 v44, v34, v2
    v_and_b32 v45, v34, v3
    v_and_b32_dpp v46, v34, v4 row_half_mirror row_mask:0xf bank_mask:0xf
    v_and_b32_dpp v47, v34, v5 row_half_mirror row_mask:0xf bank_mask:0xf
    v_and_b32_dpp v48, v34, v2 row_half_mirror row_mask:0xf bank_mask:0xf
    v_and_b32_dpp v49, v34, v3 row_half_mirror row_mask:0xf bank_mask:0xf
    v_and_b32 v50, v34, v4
    v_and_b32 v51, v34, v5
    v_mfma_f32_16x16x32_bf16 v[16:19], v[52:55], v[200:203], v[16:19]
    v_mfma_f32_16x16x32_bf16 v[16:19], v[56:59], v[204:207], v[16:19]
    v_and_b32 v52, v35, v2
    v_and_b32 v53, v35, v3
    v_and_b32_dpp v54, v35, v4 row_half_mirror row_mask:0xf bank_mask:0xf
    v_and_b32_dpp v55, v35, v5 row_half_mirror row_mask:0xf bank_mask:0xf
    v_and_b32_dpp v56, v35, v2 row_half_mirror row_mask:0xf bank_mask:0xf
    v_and_b32_dpp v57, v35, v3 row_half_mirror row_mask:0xf bank_mask:0xf
    v_and_b32 v58, v35, v4
    v_and_b32 v59, v35, v5
    s_waitcnt lgkmcnt(0)
    v_readfirstlane_b32 s75, v24
    s_min_u32 s75, s75, 1023
    s_lshl_b32 s75, s75, 2
    v_mov_b32 v25, s75
    ds_read_b32 v27, v25 offset:18432
    v_mfma_f32_16x16x32_bf16 v[16:19], v[44:47], v[208:211], v[16:19]
    v_mfma_f32_16x16x32_bf16 v[16:19], v[48:51], v[212:215], v[16:19]
    v_mfma_f32_16x16x32_bf16 v[16:19], v[52:55], v[216:219], v[16:19]
    v_mfma_f32_16x16x32_bf16 v[16:19], v[56:59], v[220:223], v[16:19]
    s_cbranch_execz L_pv4
L_cd4:
    s_cmp_lg_u32 s79, 0
    s_cbranch_scc1 L_dr4
    s_mov_b32 s78, 0
L_poll4:
    s_waitcnt lgkmcnt(0)
    v_readfirstlane_b32 s64, v27
    s_cmp_lg_u32 s64, -1
    s_cbranch_scc1 L_got4
    s_sleep 1
    ds_read_b32 v27, v25 offset:18432
    s_add_u32 s78, s78, 1
    s_cmp_lt_u32 s78, 2097152
    s_cbranch_scc1 L_poll4
L_got4:
    s_cmp_ge_u32 s64, 0x40000000
    s_cbranch_scc1 L_st4
    s_and_b32 s56, s64, 0x3f8
    s_lshl_b32 s56, s56, 13
    s_add_u32 s56, s56, s71
    s_and_b32 s57, s64, 3
    s_lshl_b32 s57, s57, 10
    s_or_b32 s56, s56, s57
    s_and_b32 s57, s64, 4
    s_lshl_b32 s57, s57, 12
    s_or_b32 s56, s56, s57
    s_add_u32 s57, s56, 4096
    s_add_u32 s58, s56, 8192
    s_add_u32 s59, s56, 12288
    s_add_u32 s60, s56, 32768
    s_add_u32 s61, s56, 36864
    s_add_u32 s62, s56, 40960
    s_add_u32 s63, s56, 45056
    s_bitcmp1_b32 s64, 20
    s_cbranch_scc1 L_ldv4
    buffer_load_dwordx4 v[192:195], v6, s[48:51], s56 offen offset:0 nt
    buffer_load_dwordx4 v[196:199], v6, s[48:51], s57 offen offset:0 nt
    buffer_load_dwordx4 v[200:203], v6, s[48:51], s58 offen offset:0 nt
    buffer_load_dwordx4 v[204:207], v6, s[48:51], s59 offen offset:0 nt
    buffer_load_dwordx4 v[208:211], v6, s[48:51], s60 offen offset:0 nt
    buffer_load_dwordx4 v[212:215], v6, s[48:51], s61 offen offset:0 nt
    buffer_load_dwordx4 v[216:219], v6, s[48:51], s62 offen offset:0 nt
    buffer_load_dwordx4 v[220:223], v6, s[48:51], s63 offen offset:0 nt
    s_branch L_nx4
L_pv4:
    s_branch L_pw4
L_ldv4:
    buffer_load_dwordx4 v[192:195], v7, s[52:55], s56 offen offset:0 nt
    buffer_load_dwordx4 v[196:199], v7, s[52:55], s57 offen offset:0 nt
    buffer_load_dwordx4 v[200:203], v7, s[52:55], s58 offen offset:0 nt
    buffer_load_dwordx4 v[204:207], v7, s[52:55], s59 offen offset:0 nt
    buffer_load_dwordx4 v[208:211], v7, s[52:55], s60 offen offset:0 nt
    buffer_load_dwordx4 v[212:215], v7, s[52:55], s61 offen offset:0 nt
    buffer_load_dwordx4 v[216:219], v7, s[52:55], s62 offen offset:0 nt
    buffer_load_dwordx4 v[220:223], v7, s[52:55], s63 offen offset:0 nt
    s_branch L_nx4
L_pw4:
    s_branch L_isv5
L_st4:
    s_mov_b32 s79, 2
L_dr4:
    s_sub_u32 s79, s79, 1
    s_cmp_eq_u32 s79, 0
    s_cbranch_scc1 L_sdone
L_nx4:
    s_bfe_u32 s74, s65, 0xa000a
    s_lshl_b32 s74, s74, 7
    v_add_u32 v60, s74, v61
    s_bitcmp1_b32 s65, 20
    s_cbranch_scc1 L_isv5
    s_waitcnt vmcnt(8)
    s_cmp_eq_u32 s79, 0
    s_cbranch_scc1 L_vw_14
    s_waitcnt vmcnt(0)
L_vw_14:
    s_mov_b64 exec, 1
    ds_add_rtn_u32 v24, v22, v23
    s_mov_b64 exec, -1
    v_mfma_f32_16x16x32_bf16 v[28:31], v[224:227], v[8:11], 0
    v_mfma_f32_16x16x32_bf16 v[32:35], v[232:235], v[8:11], 0
    v_mfma_f32_16x16x32_bf16 v[36:39], v[240:243], v[8:11], 0
    v_mfma_f32_16x16x32_bf16 v[40:43], v[248:251], v[8:11], 0
    v_mfma_f32_16x16x32_bf16 v[28:31], v[228:231], v[12:15], v[28:31]
    v_mfma_f32_16x16x32_bf16 v[32:35], v[236:239], v[12:15], v[32:35]
    v_mfma_f32_16x16x32_bf16 v[36:39], v[244:247], v[12:15], v[36:39]
    v_mfma_f32_16x16x32_bf16 v[40:43], v[252:255], v[12:15], v[40:43]
    s_waitcnt lgkmcnt(0)
    v_readfirstlane_b32 s75, v24
    s_min_u32 s75, s75, 1023
    s_lshl_b32 s75, s75, 2
    v_mov_b32 v25, s75
    ds_read_b32 v27, v25 offset:18432
    v_mov_b32_dpp v44, v28 quad_perm:[0,0,0,0] row_mask:0xf bank_mask:0xf
    v_mov_b32_dpp v48, v30 quad_perm:[2,2,2,2] row_mask:0xf bank_mask:0xf
    v_mov_b32_dpp v45, v32 quad_perm:[0,0,0,0] row_mask:0xf bank_mask:0xf
    v_mov_b32_dpp v49, v34 quad_perm:[2,2,2,2] row_mask:0xf bank_mask:0xf
    v_mov_b32_dpp v46, v36 quad_perm:[0,0,0,0] row_mask:0xf bank_mask:0xf
    v_mov_b32_dpp v50, v38 quad_perm:[2,2,2,2] row_mask:0xf bank_mask:0xf
    v_mov_b32_dpp v47, v40 quad_perm:[0,0,0,0] row_mask:0xf bank_mask:0xf
    v_mov_b32_dpp v51, v42 quad_perm:[2,2,2,2] row_mask:0xf bank_mask:0xf
    v_add_f32_dpp v44, v29, v44 quad_perm:[1,1,1,1] row_mask:0xf bank_mask:0xf
    v_add_f32_dpp v48, v31, v48 quad_perm:[3,3,3,3] row_mask:0xf bank_mask:0xf
    v_add_f32_dpp v45, v33, v45 quad_perm:[1,1,1,1] row_mask:0xf bank_mask:0xf
    v_add_f32_dpp v49, v35, v49 quad_perm:[3,3,3,3] row_mask:0xf bank_mask:0xf
    v_add_f32_dpp v46, v37, v46 quad_perm:[1,1,1,1] row_mask:0xf bank_mask:0xf
    v_add_f32_dpp v50, v39, v50 quad_perm:[3,3,3,3] row_mask:0xf bank_mask:0xf
    v_add_f32_dpp v47, v41, v47 quad_perm:[1,1,1,1] row_mask:0xf bank_mask:0xf
    v_add_f32_dpp v51, v43, v51 quad_perm:[3,3,3,3] row_mask:0xf bank_mask:0xf
    v_add_f32 v44, v44, v48
    v_add_f32 v45, v45, v49
    v_add_f32 v46, v46, v50
    v_add_f32 v47, v47, v51
    v_cvt_pk_bf16_f32 v48, v44, v45
    v_lshlrev_b32 v44, 16, v48
    v_and_b32 v45, 0xffff0000, v48
    v_cvt_pk_bf16_f32 v49, v46, v47
    v_lshlrev_b32 v46, 16, v49
    v_and_b32 v47, 0xffff0000, v49
    v_mul_f32 v44, s10, v44
    v_mul_f32 v45, s10, v45
    v_mul_f32 v46, s10, v46
    v_mul_f32 v47, s10, v47
    v_cvt_pk_bf16_f32 v48, v44, v45
    v_cvt_pk_bf16_f32 v49, v46, v47
    v_min_u32 v48, -2, v48
    v_min_u32 v49, -2, v49
    ds_write_b64 v60, v[48:49]
    s_branch L_cd5
L_isv5:
    ds_read_b64 v[62:63], v60
    s_mov_b32 s78, 0
L_sw5:
    s_waitcnt lgkmcnt(0)
    v_max_u32 v39, v62, v63
    v_cmp_eq_u32 vcc, -1, v39
    s_cbranch_vccz L_sok5
    ds_read_b64 v[62:63], v60
    s_add_u32 s78, s78, 1
    s_cmp_lt_u32 s78, 4194304
    s_cbranch_scc1 L_sw5
L_sok5:
    v_lshlrev_b32 v28, 16, v62
    v_and_b32 v29, 0xffff0000, v62
    v_lshlrev_b32 v30, 16, v63
    v_and_b32 v31, 0xffff0000, v63
    v_max3_f32 v39, v28, v29, v30
    v_max_f32 v39, v39, v31
    v_cmp_gt_f32 vcc, v39, v20
    s_cbranch_vccz L_back5
    s_call_b64 s[80:81], L_slow
L_back5:
    v_fma_f32 v28, v28, s11, v26
    v_fma_f32 v29, v29, s11, v26
    v_fma_f32 v30, v30, s11, v26
    v_fma_f32 v31, v31, s11, v26
    v_exp_f32 v28, v28
    v_exp_f32 v29, v29
    v_exp_f32 v30, v30
    v_exp_f32 v31, v31
    v_cvt_pk_bf16_f32 v32, v28, v28
    v_cvt_pk_bf16_f32 v33, v29, v29
    v_cvt_pk_bf16_f32 v34, v30, v30
    v_cvt_pk_bf16_f32 v35, v31, v31
    v_add_f32 v36, v28, v29
    v_add_f32 v37, v30, v31
    v_and_b32 v44, v32, v2
    v_and_b32 v45, v32, v3
    v_and_b32_dpp v46, v32, v4 row_half_mirror row_mask:0xf bank_mask:0xf
    v_and_b32_dpp v47, v32, v5 row_half_mirror row_mask:0xf bank_mask:0xf
    v_and_b32_dpp v48, v32, v2 row_half_mirror row_mask:0xf bank_mask:0xf
    v_and_b32_dpp v49, v32, v3 row_half_mirror row_mask:0xf bank_mask:0xf
    v_and_b32 v50, v32, v4
    v_and_b32 v51, v32, v5
    v_and_b32 v52, v33, v2
    v_and_b32 v53, v33, v3
    v_and_b32_dpp v54, v33, v4 row_half_mirror row_mask:0xf bank_mask:0xf
    v_and_b32_dpp v55, v33, v5 row_half_mirror row_mask:0xf bank_mask:0xf
    v_and_b32_dpp v56, v33, v2 row_half_mirror row_mask:0xf bank_mask:0xf
    v_and_b32_dpp v57, v33, v3 row_half_mirror row_mask:0xf bank_mask:0xf
    v_and_b32 v58, v33, v4
    v_and_b32 v59, v33, v5
    v_add_f32 v21, v21, v36
    v_add_f32 v21, v21, v37
    s_cbranch_execz L_g_15
    s_waitcnt vmcnt(8)
    s_cmp_eq_u32 s79, 0
    s_cbranch_scc1 L_vw_16
    s_waitcnt vmcnt(0)
L_vw_16:
    s_mov_b64 exec, 1
    ds_add_rtn_u32 v24, v22, v23
    s_mov_b64 exec, -1
L_g_15:
    v_mfma_f32_16x16x32_bf16 v[16:19], v[44:47], v[224:227], v[16:19]
    v_mfma_f32_16x16x32_bf16 v[16:19], v[48:51], v[228:231], v[16:19]
    v_and_b32 v44, v34, v2
    v_and_b32 v45, v34, v3
    v_and_b32_dpp v46, v34, v4 row_half_mirror row_mask:0xf bank_mask:0xf
    v_and_b32_dpp v47, v34, v5 row_half_mirror row_mask:0xf bank_mask:0xf
    v_and_b32_dpp v48, v34, v2 row_half_mirror row_mask:0xf bank_mask:0xf
    v_and_b32_dpp v49, v34, v3 row_half_mirror row_mask:0xf bank_mask:0xf
    v_and_b32 v50, v34, v4
    v_and_b32 v51, v34, v5
    v_mfma_f32_16x16x32_bf16 v[16:19], v[52:55], v[232:235], v[16:19]
    v_mfma_f32_16x16x32_bf16 v[16:19], v[56:59], v[236:239], v[16:19]
    v_and_b32 v52, v35, v2
    v_and_b32 v53, v35, v3
    v_and_b32_dpp v54, v35, v4 row_half_mirror row_mask:0xf bank_mask:0xf
    v_and_b32_dpp v55, v35, v5 row_half_mirror row_mask:0xf bank_mask:0xf
    v_and_b32_dpp v56, v35, v2 row_half_mirror row_mask:0xf bank_mask:0xf
    v_and_b32_dpp v57, v35, v3 row_half_mirror row_mask:0xf bank_mask:0xf
    v_and_b32 v58, v35, v4
    v_and_b32 v59, v35, v5
    s_waitcnt lgkmcnt(0)
    v_readfirstlane_b32 s75, v24
    s_min_u32 s75, s75, 1023
    s_lshl_b32 s75, s75, 2
    v_mov_b32 v25, s75
    ds_read_b32 v27, v25 offset:18432
    v_mfma_f32_16x16x32_bf16 v[16:19], v[44:47], v[240:243], v[16:19]
    v_mfma_f32_16x16x32_bf16 v[16:19], v[48:51], v[244:247], v[16:19]
    v_mfma_f32_16x16x32_bf16 v[16:19], v[52:55], v[248:251], v[16:19]
    v_mfma_f32_16x16x32_bf16 v[16:19], v[56:59], v[252:255], v[16:19]
    s_cbranch_execz L_pv5
L_cd5:
    s_cmp_lg_u32 s79, 0
    s_cbranch_scc1 L_dr5
    s_mov_b32 s78, 0
L_poll5:
    s_waitcnt lgkmcnt(0)
    v_readfirstlane_b32 s65, v27
    s_cmp_lg_u32 s65, -1
    s_cbranch_scc1 L_got5
    s_sleep 1
    ds_read_b32 v27, v25 offset:18432
    s_add_u32 s78, s78, 1
    s_cmp_lt_u32 s78, 2097152
    s_cbranch_scc1 L_poll5
L_got5:
    s_cmp_ge_u32 s65, 0x40000000
    s_cbranch_scc1 L_st5
    s_and_b32 s56, s65, 0x3f8
    s_lshl_b32 s56, s56, 13
    s_add_u32 s56, s56, s71
    s_and_b32 s57, s65, 3
    s_lshl_b32 s57, s57, 10
    s_or_b32 s56, s56, s57
    s_and_b32 s57, s65, 4
    s_lshl_b32 s57, s57, 12
    s_or_b32 s56, s56, s57
    s_add_u32 s57, s56, 4096
    s_add_u32 s58, s56, 8192
    s_add_u32 s59, s56, 12288
    s_add_u32 s60, s56, 32768
    s_add_u32 s61, s56, 36864
    s_add_u32 s62, s56, 40960
    s_add_u32 s63, s56, 45056
    s_bitcmp1_b32 s65, 20
    s_cbranch_scc1 L_ldv5
    buffer_load_dwordx4 v[224:227], v6, s[48:51], s56 offen offset:0 nt
    buffer_load_dwordx4 v[228:231], v6, s[48:51], s57 offen offset:0 nt
    buffer_load_dwordx4 v[232:235], v6, s[48:51], s58 offen offset:0 nt
    buffer_load_dwordx4 v[236:239], v6, s[48:51], s59 offen offset:0 nt
    buffer_load_dwordx4 v[240:243], v6, s[48:51], s60 offen offset:0 nt
    buffer_load_dwordx4 v[244:247], v6, s[48:51], s61 offen offset:0 nt
    buffer_load_dwordx4 v[248:251], v6, s[48:51], s62 offen offset:0 nt
    buffer_load_dwordx4 v[252:255], v6, s[48:51], s63 offen offset:0 nt
    s_branch L_nx5
L_pv5:
    s_branch L_pw5
L_ldv5:
    buffer_load_dwordx4 v[224:227], v7, s[52:55], s56 offen offset:0 nt
    buffer_load_dwordx4 v[228:231], v7, s[52:55], s57 offen offset:0 nt
    buffer_load_dwordx4 v[232:235], v7, s[52:55], s58 offen offset:0 nt
    buffer_load_dwordx4 v[236:239], v7, s[52:55], s59 offen offset:0 nt
    buffer_load_dwordx4 v[240:243], v7, s[52:55], s60 offen offset:0 nt
    buffer_load_dwordx4 v[244:247], v7, s[52:55], s61 offen offset:0 nt
    buffer_load_dwordx4 v[248:251], v7, s[52:55], s62 offen offset:0 nt
    buffer_load_dwordx4 v[252:255], v7, s[52:55], s63 offen offset:0 nt
    s_branch L_nx5
L_pw5:
    s_branch L_sdone
L_st5:
    s_mov_b32 s79, 2
L_dr5:
    s_sub_u32 s79, s79, 1
    s_cmp_eq_u32 s79, 0
    s_cbranch_scc1 L_sdone
L_nx5:
    s_branch L_loop
L_slow:
    s_nop 7
    v_max_f32 v39, v39, v20
    s_nop 1
    v_max_f32_dpp v39, v39, v39 row_half_mirror row_mask:0xf bank_mask:0xf
    v_mov_b32 v42, v39
    s_nop 1
    v_permlane16_swap_b32 v42, v39
    v_max_f32 v39, v39, v42
    v_mov_b32 v42, v39
    s_nop 1
    v_permlane32_swap_b32 v42, v39
    v_max_f32 v20, v39, v42
    v_mul_f32 v42, s11, v20
    v_add_f32 v43, v42, v26
    v_exp_f32 v43, -v43
    v_sub_f32 v26, 0, v42
    v_mul_f32 v21, v21, v43
    v_mov_b32_dpp v42, v43 row_ror:8 row_mask:0xf bank_mask:0xf
    v_cndmask_b32 v42, v43, v42, s[76:77]
    v_mul_f32 v16, v16, v42
    v_mul_f32 v17, v17, v42
    v_mul_f32 v18, v18, v42
    v_mul_f32 v19, v19, v42
    s_setpc_b64 s[80:81]
L_sdone:
    s_cbranch_execz L_g_17
    s_cmp_ge_u32 s73, 2
    s_cbranch_scc1 L_retired
L_g_17:
L_pub:
    v_add_f32_dpp v21, v21, v21 row_half_mirror row_mask:0xf bank_mask:0xf
    s_lshl_b32 s74, s73, 10
    v_add_u32 v25, s74, v7
    v_mov_b32 v42, v21
    s_nop 1
    v_permlane16_swap_b32 v42, v21
    v_add_f32 v21, v21, v42
    ds_write_b128 v25, v[16:19] offset:10240
    v_mov_b32 v42, v21
    s_nop 1
    v_permlane32_swap_b32 v42, v21
    v_add_f32 v43, v21, v42
    v_sub_f32 v42, 0, v26
    s_lshl_b32 s74, s73, 4
    v_add_u32 v25, s74, v1
    s_cbranch_execz L_g_18
    s_mov_b64 exec, 0x101
    ds_write_b64 v25, v[42:43] offset:8704
    s_mov_b64 exec, 1
    ds_add_rtn_u32 v24, v22, v23 offset:28
    s_mov_b64 exec, -1
L_g_18:
    v_lshrrev_b32 v27, 5, v1
    v_lshlrev_b32 v28, 3, v27
    ds_read_b64 v[72:73], v28 offset:8704
    ds_read_b64 v[74:75], v28 offset:8720
    ds_read_b128 v[64:67], v7 offset:10240
    ds_read_b128 v[68:71], v7 offset:11264
    v_lshlrev_b32 v30, 7, v27
    v_lshlrev_b32 v29, 9, v27
    v_and_b32 v31, 15, v1
    v_lshl_add_u32 v29, v31, 5, v29
    v_bfe_u32 v31, v1, 4, 1
    v_lshl_add_u32 v29, v31, 4, v29
    s_waitcnt lgkmcnt(2)
    v_readfirstlane_b32 s75, v24
    s_cbranch_execz L_g_19
    s_cmp_lg_u32 s75, 1
    s_cbranch_scc1 M_end
L_g_19:
    v_max_f32 v32, v72, v74
    v_sub_f32 v72, v72, v32
    v_sub_f32 v74, v74, v32
    v_exp_f32 v72, v72
    v_exp_f32 v74, v74
    s_waitcnt lgkmcnt(0)
    v_mul_f32 v36, v64, v72
    v_mul_f32 v37, v65, v72
    v_mul_f32 v38, v66, v72
    v_mul_f32 v39, v67, v72
    v_fmac_f32 v36, v68, v74
    v_fmac_f32 v37, v69, v74
    v_fmac_f32 v38, v70, v74
    v_fmac_f32 v39, v71, v74
    v_mul_f32 v33, v72, v73
    v_fmac_f32 v33, v74, v75
    v_min_u32 v36, -2, v36
    v_min_u32 v37, -2, v37
    v_min_u32 v38, -2, v38
    v_min_u32 v39, -2, v39
    v_min_u32 v32, -2, v32
    v_min_u32 v33, -2, v33
    s_cbranch_execz L_dryret
    buffer_store_dwordx4 v[36:39], v29, s[44:47], s68 offen sc1
    s_mov_b32 exec_lo, 0x1
    s_mov_b32 exec_hi, 0x1
    buffer_store_dwordx2 v[32:33], v30, s[44:47], s69 offen sc1
    s_endpgm
L_skip:
L_retired:
    s_cmp_lg_u32 s73, 2
    s_cbranch_scc1 L_dryend
    s_mov_b64 exec, 0
    s_call_b64 s[80:81], L_slow
    s_branch L_isv4
L_dryret:
    s_endpgm
L_dryend:
    s_cmp_lt_u32 s73, 4
    s_cbranch_scc1 M_end
    s_add_u32 s60, s6, s7
    s_and_b32 s60, s60, 7
    s_cmp_lg_u32 s60, 0
    s_cbranch_scc1 M_end
    s_cmp_ge_u32 s7, 18
    s_cbranch_scc1 M_end
    s_setprio 3
    s_mov_b32 s44, s38
    s_mov_b32 s45, s39
    s_mov_b32 s46, 0x800000
    s_mov_b32 s47, 0x20000
    s_mov_b32 s40, s16
    s_mov_b32 s41, s17
    s_mov_b32 s42, 0x900
    s_mov_b32 s43, 0x20000
    v_mov_b32 v9, 2048
    ds_read_b64 v[10:11], v9 offset:8
    s_mul_i32 s66, s5, 1152
    s_lshl_b32 s60, s4, 7
    s_add_u32 s66, s66, s60
    v_and_b32 v12, 15, v1
    v_lshlrev_b32 v13, 3, v12
    v_lshlrev_b32 v12, 4, v12
    buffer_load_dwordx2 v[14:15], v13, s[40:43], s66 offen
    v_lshlrev_b32 v16, 4, v1
    s_mov_b32 s60, 327680
    s_waitcnt lgkmcnt(0)
    v_readfirstlane_b32 s12, v10
    v_readfirstlane_b32 s13, v11
    v_lshrrev_b32 v17, 4, v1
    s_add_u32 s62, s4, 0
    s_lshr_b32 s63, s62, 1
    s_and_b32 s62, s62, 1
    s_lshl_b32 s62, s62, 9
    v_lshlrev_b32 v18, 2, v17
    v_sub_u32 v18, s63, v18
    v_and_b32 v18, 31, v18
    v_lshl_add_u32 v18, v18, 3, v17
    v_lshl_add_u32 v128, v18, 11, v12
    v_add_u32 v128, s62, v128
    s_add_u32 s62, s4, 9
    s_lshr_b32 s63, s62, 1
    s_and_b32 s62, s62, 1
    s_lshl_b32 s62, s62, 9
    v_lshlrev_b32 v18, 2, v17
    v_sub_u32 v18, s63, v18
    v_and_b32 v18, 31, v18
    v_lshl_add_u32 v18, v18, 3, v17
    v_lshl_add_u32 v130, v18, 11, v12
    v_add_u32 v130, s62, v130
    s_add_u32 s62, s4, 18
    s_lshr_b32 s63, s62, 1
    s_and_b32 s62, s62, 1
    s_lshl_b32 s62, s62, 9
    v_lshlrev_b32 v18, 2, v17
    v_sub_u32 v18, s63, v18
    v_and_b32 v18, 31, v18
    v_lshl_add_u32 v18, v18, 3, v17
    v_lshl_add_u32 v132, v18, 11, v12
    v_add_u32 v132, s62, v132
    s_add_u32 s62, s4, 27
    s_lshr_b32 s63, s62, 1
    s_and_b32 s62, s62, 1
    s_lshl_b32 s62, s62, 9
    v_lshlrev_b32 v18, 2, v17
    v_sub_u32 v18, s63, v18
    v_and_b32 v18, 31, v18
    v_lshl_add_u32 v18, v18, 3, v17
    v_lshl_add_u32 v134, v18, 11, v12
    v_add_u32 v134, s62, v134
    s_add_u32 s62, s4, 36
    s_lshr_b32 s63, s62, 1
    s_and_b32 s62, s62, 1
    s_lshl_b32 s62, s62, 9
    v_lshlrev_b32 v18, 2, v17
    v_sub_u32 v18, s63, v18
    v_and_b32 v18, 31, v18
    v_lshl_add_u32 v18, v18, 3, v17
    v_lshl_add_u32 v136, v18, 11, v12
    v_add_u32 v136, s62, v136
    s_add_u32 s62, s4, 45
    s_lshr_b32 s63, s62, 1
    s_and_b32 s62, s62, 1
    s_lshl_b32 s62, s62, 9
    v_lshlrev_b32 v18, 2, v17
    v_sub_u32 v18, s63, v18
    v_and_b32 v18, 31, v18
    v_lshl_add_u32 v18, v18, 3, v17
    v_lshl_add_u32 v138, v18, 11, v12
    v_add_u32 v138, s62, v138
    s_add_u32 s62, s4, 54
    s_lshr_b32 s63, s62, 1
    s_and_b32 s62, s62, 1
    s_lshl_b32 s62, s62, 9
    v_lshlrev_b32 v18, 2, v17
    v_sub_u32 v18, s63, v18
    v_and_b32 v18, 31, v18
    v_lshl_add_u32 v18, v18, 3, v17
    v_lshl_add_u32 v140, v18, 11, v12
    v_add_u32 v140, s62, v140
    v_add_u32 v17, 4, v17
    s_add_u32 s62, s4, 0
    s_lshr_b32 s63, s62, 1
    s_and_b32 s62, s62, 1
    s_lshl_b32 s62, s62, 9
    v_lshlrev_b32 v18, 2, v17
    v_sub_u32 v18, s63, v18
    v_and_b32 v18, 31, v18
    v_lshl_add_u32 v18, v18, 3, v17
    v_lshl_add_u32 v129, v18, 11, v12
    v_add_u32 v129, s62, v129
    s_add_u32 s62, s4, 9
    s_lshr_b32 s63, s62, 1
    s_and_b32 s62, s62, 1
    s_lshl_b32 s62, s62, 9
    v_lshlrev_b32 v18, 2, v17
    v_sub_u32 v18, s63, v18
    v_and_b32 v18, 31, v18
    v_lshl_add_u32 v18, v18, 3, v17
    v_lshl_add_u32 v131, v18, 11, v12
    v_add_u32 v131, s62, v131
    s_add_u32 s62, s4, 18
    s_lshr_b32 s63, s62, 1
    s_and_b32 s62, s62, 1
    s_lshl_b32 s62, s62, 9
    v_lshlrev_b32 v18, 2, v17
    v_sub_u32 v18, s63, v18
    v_and_b32 v18, 31, v18
    v_lshl_add_u32 v18, v18, 3, v17
    v_lshl_add_u32 v133, v18, 11, v12
    v_add_u32 v133, s62, v133
    s_add_u32 s62, s4, 27
    s_lshr_b32 s63, s62, 1
    s_and_b32 s62, s62, 1
    s_lshl_b32 s62, s62, 9
    v_lshlrev_b32 v18, 2, v17
    v_sub_u32 v18, s63, v18
    v_and_b32 v18, 31, v18
    v_lshl_add_u32 v18, v18, 3, v17
    v_lshl_add_u32 v135, v18, 11, v12
    v_add_u32 v135, s62, v135
    s_add_u32 s62, s4, 36
    s_lshr_b32 s63, s62, 1
    s_and_b32 s62, s62, 1
    s_lshl_b32 s62, s62, 9
    v_lshlrev_b32 v18, 2, v17
    v_sub_u32 v18, s63, v18
    v_and_b32 v18, 31, v18
    v_lshl_add_u32 v18, v18, 3, v17
    v_lshl_add_u32 v137, v18, 11, v12
    v_add_u32 v137, s62, v137
    s_add_u32 s62, s4, 45
    s_lshr_b32 s63, s62, 1
    s_and_b32 s62, s62, 1
    s_lshl_b32 s62, s62, 9
    v_lshlrev_b32 v18, 2, v17
    v_sub_u32 v18, s63, v18
    v_and_b32 v18, 31, v18
    v_lshl_add_u32 v18, v18, 3, v17
    v_lshl_add_u32 v139, v18, 11, v12
    v_add_u32 v139, s62, v139
    s_add_u32 s62, s4, 54
    s_lshr_b32 s63, s62, 1
    s_and_b32 s62, s62, 1
    s_lshl_b32 s62, s62, 9
    v_lshlrev_b32 v18, 2, v17
    v_sub_u32 v18, s63, v18
    v_and_b32 v18, 31, v18
    v_lshl_add_u32 v18, v18, 3, v17
    v_lshl_add_u32 v141, v18, 11, v12
    v_add_u32 v141, s62, v141
    s_lshl_b32 s68, s5, 8
    s_add_u32 s68, s68, 1049600
    s_mov_b32 s67, 0
L_pl_20:
    buffer_load_dwordx4 v[28:31], v16, s[44:47], s60 offen offset:0 sc1
    buffer_load_dwordx4 v[32:35], v16, s[44:47], s60 offen offset:1024 sc1
    buffer_load_dwordx4 v[36:39], v16, s[44:47], s60 offen offset:2048 sc1
    buffer_load_dwordx4 v[40:43], v16, s[44:47], s60 offen offset:3072 sc1
    s_waitcnt vmcnt(0)
    v_bitop3_b32 v9, v29, v30, s12 bitop3:0x96
    v_bitop3_b32 v10, v31, v28, s13 bitop3:0x96
    v_or_b32 v8, v9, v10
    v_bitop3_b32 v9, v33, v34, s12 bitop3:0x96
    v_bitop3_b32 v10, v35, v32, s13 bitop3:0x96
    v_or3_b32 v8, v8, v9, v10
    v_bitop3_b32 v9, v37, v38, s12 bitop3:0x96
    v_bitop3_b32 v10, v39, v36, s13 bitop3:0x96
    v_or3_b32 v8, v8, v9, v10
    v_bitop3_b32 v9, v41, v42, s12 bitop3:0x96
    v_bitop3_b32 v10, v43, v40, s13 bitop3:0x96
    v_or3_b32 v8, v8, v9, v10
    v_cmp_ne_u32 vcc, 0, v8
    s_cbranch_vccz L_pl_20_ok
    s_sleep 64
    s_add_u32 s67, s67, 1
    s_cmp_lt_u32 s67, 262144
    s_cbranch_scc1 L_pl_20
L_pl_20_ok:
    v_lshlrev_b32 v24, 16, v14
    v_and_b32 v25, 0xffff0000, v14
    v_lshlrev_b32 v26, 16, v15
    v_and_b32 v27, 0xffff0000, v15
    s_mov_b32 s40, s34
    s_mov_b32 s41, s35
    s_mov_b32 s42, 0x900
    s_mov_b32 s43, 0x20000
    v_mov_b32 v9, 2076
    s_mov_b32 s67, 0
L_fw_21:
    ds_read_b32 v8, v9
    s_waitcnt lgkmcnt(0)
    v_readfirstlane_b32 s60, v8
    s_cmp_ge_u32 s60, 2
    s_cbranch_scc1 L_fw_21_ok
    s_sleep 8
    s_add_u32 s67, s67, 1
    s_cmp_lt_u32 s67, 4194304
    s_cbranch_scc1 L_fw_21
L_fw_21_ok:
    v_mov_b32 v21, 2048
    v_mov_b32 v20, 1
    s_cmp_eq_u32 s73, 5
    s_cbranch_scc1 L_fin2
    s_mov_b32 s67, 0
    buffer_load_dwordx4 v[96:99], v136, s[44:47], s68 offen sc1
    buffer_load_dwordx4 v[100:103], v137, s[44:47], s68 offen sc1
    buffer_load_dwordx4 v[104:107], v138, s[44:47], s68 offen sc1
    buffer_load_dwordx4 v[108:111], v139, s[44:47], s68 offen sc1
    buffer_load_dwordx4 v[112:115], v140, s[44:47], s68 offen sc1
    buffer_load_dwordx4 v[116:119], v141, s[44:47], s68 offen sc1
    s_sleep 2
L_pp_22:
    buffer_load_dwordx4 v[96:99], v136, s[44:47], s68 offen sc1
    buffer_load_dwordx4 v[100:103], v137, s[44:47], s68 offen sc1
    buffer_load_dwordx4 v[104:107], v138, s[44:47], s68 offen sc1
    buffer_load_dwordx4 v[108:111], v139, s[44:47], s68 offen sc1
    buffer_load_dwordx4 v[112:115], v140, s[44:47], s68 offen sc1
    buffer_load_dwordx4 v[116:119], v141, s[44:47], s68 offen sc1
    s_waitcnt vmcnt(6)
    v_max3_u32 v8, v96, v97, v98
    v_max3_u32 v9, v99, v100, v101
    v_max3_u32 v8, v8, v102, v103
    v_max3_u32 v9, v9, v104, v105
    v_max3_u32 v8, v8, v106, v107
    v_max3_u32 v9, v9, v108, v109
    v_max3_u32 v8, v8, v110, v111
    v_max3_u32 v9, v9, v112, v113
    v_max3_u32 v8, v8, v114, v115
    v_max3_u32 v9, v9, v116, v117
    v_max3_u32 v8, v8, v118, v119
    v_max_u32 v8, v8, v9
    v_cmp_eq_u32 vcc, -1, v8
    s_cbranch_vccz L_fin3_ok
    s_add_u32 s67, s67, 1
    s_cmp_lt_u32 s67, 262144
    s_cbranch_scc1 L_pp_22
L_fin3_ok:
    v_add_f32 v28, v96, v108
    v_add_f32 v29, v97, v109
    v_add_f32 v30, v98, v110
    v_add_f32 v31, v99, v111
    v_add_f32 v32, v100, v112
    v_add_f32 v33, v101, v113
    v_add_f32 v34, v102, v114
    v_add_f32 v35, v103, v115
    v_add_f32 v36, v104, v116
    v_add_f32 v37, v105, v117
    v_add_f32 v38, v106, v118
    v_add_f32 v39, v107, v119
    v_add_f32 v32, v32, v36
    v_add_f32 v33, v33, v37
    v_add_f32 v34, v34, v38
    v_add_f32 v35, v35, v39
    v_add_f32 v28, v28, v32
    v_add_f32 v29, v29, v33
    v_add_f32 v30, v30, v34
    v_add_f32 v31, v31, v35
    v_mov_b32 v32, v28
    v_mov_b32 v33, v29
    v_mov_b32 v34, v30
    v_mov_b32 v35, v31
    v_permlane16_swap_b32 v32, v28
    v_permlane16_swap_b32 v33, v29
    v_permlane16_swap_b32 v34, v30
    v_permlane16_swap_b32 v35, v31
    v_add_f32 v28, v28, v32
    v_add_f32 v29, v29, v33
    v_add_f32 v30, v30, v34
    v_add_f32 v31, v31, v35
    v_mov_b32 v32, v28
    v_mov_b32 v33, v29
    v_mov_b32 v34, v30
    v_mov_b32 v35, v31
    v_permlane32_swap_b32 v32, v28
    v_permlane32_swap_b32 v33, v29
    v_permlane32_swap_b32 v34, v30
    v_permlane32_swap_b32 v35, v31
    v_add_f32 v28, v28, v32
    v_add_f32 v29, v29, v33
    v_add_f32 v30, v30, v34
    v_add_f32 v31, v31, v35
    v_cvt_pk_bf16_f32 v8, v28, v29
    v_lshlrev_b32 v28, 16, v8
    v_and_b32 v29, 0xffff0000, v8
    v_cvt_pk_bf16_f32 v9, v30, v31
    v_lshlrev_b32 v30, 16, v9
    v_and_b32 v31, 0xffff0000, v9
    ds_write_b128 v12, v[28:31] offset:9216
    ds_write_b32 v21, v20 offset:32
    s_endpgm
L_fin2:
    s_mov_b32 s67, 0
    buffer_load_dwordx4 v[64:67], v128, s[44:47], s68 offen sc1
    buffer_load_dwordx4 v[68:71], v129, s[44:47], s68 offen sc1
    buffer_load_dwordx4 v[72:75], v130, s[44:47], s68 offen sc1
    buffer_load_dwordx4 v[76:79], v131, s[44:47], s68 offen sc1
    buffer_load_dwordx4 v[80:83], v132, s[44:47], s68 offen sc1
    buffer_load_dwordx4 v[84:87], v133, s[44:47], s68 offen sc1
    buffer_load_dwordx4 v[88:91], v134, s[44:47], s68 offen sc1
    buffer_load_dwordx4 v[92:95], v135, s[44:47], s68 offen sc1
    s_sleep 2
L_pp_23:
    buffer_load_dwordx4 v[64:67], v128, s[44:47], s68 offen sc1
    buffer_load_dwordx4 v[68:71], v129, s[44:47], s68 offen sc1
    buffer_load_dwordx4 v[72:75], v130, s[44:47], s68 offen sc1
    buffer_load_dwordx4 v[76:79], v131, s[44:47], s68 offen sc1
    buffer_load_dwordx4 v[80:83], v132, s[44:47], s68 offen sc1
    buffer_load_dwordx4 v[84:87], v133, s[44:47], s68 offen sc1
    buffer_load_dwordx4 v[88:91], v134, s[44:47], s68 offen sc1
    buffer_load_dwordx4 v[92:95], v135, s[44:47], s68 offen sc1
    s_waitcnt vmcnt(8)
    v_max3_u32 v8, v64, v65, v66
    v_max3_u32 v9, v67, v68, v69
    v_max3_u32 v8, v8, v70, v71
    v_max3_u32 v9, v9, v72, v73
    v_max3_u32 v8, v8, v74, v75
    v_max3_u32 v9, v9, v76, v77
    v_max3_u32 v8, v8, v78, v79
    v_max3_u32 v9, v9, v80, v81
    v_max3_u32 v8, v8, v82, v83
    v_max3_u32 v9, v9, v84, v85
    v_max3_u32 v8, v8, v86, v87
    v_max3_u32 v9, v9, v88, v89
    v_max3_u32 v8, v8, v90, v91
    v_max3_u32 v9, v9, v92, v93
    v_max3_u32 v8, v8, v94, v95
    v_max_u32 v8, v8, v9
    v_cmp_eq_u32 vcc, -1, v8
    s_cbranch_vccz L_fin_ok
    s_add_u32 s67, s67, 1
    s_cmp_lt_u32 s67, 262144
    s_cbranch_scc1 L_pp_23
L_fin_ok:
    ds_read_b32 v20, v21 offset:32
    ds_read_b128 v[28:31], v12 offset:9216
    v_add_f32 v44, v64, v80
    v_add_f32 v45, v65, v81
    v_add_f32 v46, v66, v82
    v_add_f32 v47, v67, v83
    v_add_f32 v48, v68, v84
    v_add_f32 v49, v69, v85
    v_add_f32 v50, v70, v86
    v_add_f32 v51, v71, v87
    v_add_f32 v52, v72, v88
    v_add_f32 v53, v73, v89
    v_add_f32 v54, v74, v90
    v_add_f32 v55, v75, v91
    v_add_f32 v56, v76, v92
    v_add_f32 v57, v77, v93
    v_add_f32 v58, v78, v94
    v_add_f32 v59, v79, v95
    v_add_f32 v48, v48, v56
    v_add_f32 v49, v49, v57
    v_add_f32 v50, v50, v58
    v_add_f32 v51, v51, v59
    v_add_f32 v48, v48, v52
    v_add_f32 v49, v49, v53
    v_add_f32 v50, v50, v54
    v_add_f32 v51, v51, v55
    v_add_f32 v44, v44, v48
    v_add_f32 v45, v45, v49
    v_add_f32 v46, v46, v50
    v_add_f32 v47, v47, v51
    v_mov_b32 v48, v44
    v_mov_b32 v49, v45
    v_mov_b32 v50, v46
    v_mov_b32 v51, v47
    v_permlane16_swap_b32 v48, v44
    v_permlane16_swap_b32 v49, v45
    v_permlane16_swap_b32 v50, v46
    v_permlane16_swap_b32 v51, v47
    v_add_f32 v44, v44, v48
    v_add_f32 v45, v45, v49
    v_add_f32 v46, v46, v50
    v_add_f32 v47, v47, v51
    v_mov_b32 v48, v44
    v_mov_b32 v49, v45
    v_mov_b32 v50, v46
    v_mov_b32 v51, v47
    v_permlane32_swap_b32 v48, v44
    v_permlane32_swap_b32 v49, v45
    v_permlane32_swap_b32 v50, v46
    v_permlane32_swap_b32 v51, v47
    v_add_f32 v44, v44, v48
    v_add_f32 v45, v45, v49
    v_add_f32 v46, v46, v50
    v_add_f32 v47, v47, v51
    v_cvt_pk_bf16_f32 v8, v44, v45
    v_lshlrev_b32 v44, 16, v8
    v_and_b32 v45, 0xffff0000, v8
    v_cvt_pk_bf16_f32 v9, v46, v47
    v_lshlrev_b32 v46, 16, v9
    v_and_b32 v47, 0xffff0000, v9
    v_add_f32 v44, v44, v24
    v_add_f32 v45, v45, v25
    v_add_f32 v46, v46, v26
    v_add_f32 v47, v47, v27
    v_cvt_pk_bf16_f32 v8, v44, v45
    v_lshlrev_b32 v44, 16, v8
    v_and_b32 v45, 0xffff0000, v8
    v_cvt_pk_bf16_f32 v9, v46, v47
    v_lshlrev_b32 v46, 16, v9
    v_and_b32 v47, 0xffff0000, v9
    s_mov_b32 s67, 0
L_fw3:
    s_waitcnt lgkmcnt(0)
    v_readfirstlane_b32 s60, v20
    s_cmp_lg_u32 s60, 0
    s_cbranch_scc1 L_fw3_ok
    ds_read_b32 v20, v21 offset:32
    ds_read_b128 v[28:31], v12 offset:9216
    s_add_u32 s67, s67, 1
    s_cmp_lt_u32 s67, 4194304
    s_cbranch_scc1 L_fw3
L_fw3_ok:
    v_add_f32 v44, v44, v28
    v_add_f32 v45, v45, v29
    v_add_f32 v46, v46, v30
    v_add_f32 v47, v47, v31
    v_cvt_pk_bf16_f32 v8, v44, v45
    v_cvt_pk_bf16_f32 v9, v46, v47
    s_mov_b64 exec, 0xffff
    buffer_store_dwordx2 v[8:9], v13, s[40:43], s66 offen
    s_cmp_lg_u32 s2, 0
    s_cbranch_scc1 L_fin_e
    v_mov_b32 v10, s12
    v_mov_b32 v11, s13
    v_mov_b32 v12, 0
    s_mov_b32 s62, 65536
    s_mov_b64 exec, 1
    buffer_store_dwordx2 v[10:11], v12, s[44:47], s62 offen sc1
L_fin_e:
    s_mov_b64 exec, -1
M_end:
    s_endpgm
.section .rodata,"a"
.p2align 6
.amdhsa_kernel parallel_sum__gqa_block_cached__swiglu_ffn__decode_kernel
  .amdhsa_next_free_vgpr 256
  .amdhsa_next_free_sgpr 100
  .amdhsa_accum_offset 256
  .amdhsa_group_segment_fixed_size 0
  .amdhsa_kernarg_size 96
  .amdhsa_user_sgpr_count 2
  .amdhsa_user_sgpr_kernarg_segment_ptr 1
  .amdhsa_system_sgpr_workgroup_id_x 1
  .amdhsa_float_denorm_mode_32 3
.end_amdhsa_kernel
```
